```python
import torch

def _softmax(x, axis=-1):
    return torch.softmax(x, dim=axis)
def _gelu(x):
    return torch.nn.functional.gelu(x, approximate="tanh")
def _silu(x):
    return torch.nn.functional.silu(x)
def _sigmoid(x):
    return torch.sigmoid(x)
def _layernorm(x, axis=-1, eps=1e-5):
    m = x.mean(dim=axis, keepdim=True)
    v = x.var(dim=axis, keepdim=True, unbiased=False)
    return (x - m) / torch.sqrt(v + eps)
def _scatter_add(tgt, idx, src, axis=0):
    return tgt.clone().index_add_(axis, idx, src)
def _segment_sum(src, seg, n):
    out = torch.zeros((n,) + src.shape[1:], dtype=src.dtype)
    return out.index_add_(0, seg, src)
def _pad(x, pw):
    flat = tuple(v for pair in reversed(pw) for v in pair)
    return torch.nn.functional.pad(x, flat)

kernel_name = 'standalone__fft_conv__vision'

def setup_inputs():

    _w = (lambda a: (lambda t: t.to(torch.bfloat16) if t.is_floating_point() else t)(torch.as_tensor(a)))
    H = W = 224
    C = 96
    K = 5
    return {
        "x": _w((lambda *s: torch.randn(*s, dtype=torch.bfloat16) * 0.05)(1, H, W, C)),
        "w": _w((lambda *s: torch.randn(*s, dtype=torch.bfloat16) * 0.05)(K, K, C, C)),
    }

def reference(x, w):
    B, H, W, C = x.shape
    K = w.shape[0]
    wp = _pad(w, ((0, H - K), (0, W - K), (0, 0), (0, 0)))
    Xf = (lambda x, axes=(-2,-1): torch.fft.rfft2(x.float(), dim=axes))(x, axes=(1, 2))
    Wf = (lambda x, axes=(-2,-1): torch.fft.rfft2(x.float(), dim=axes))(wp, axes=(0, 1))
    Yf = torch.einsum('bhwi,hwio->bhwo', Xf, Wf)
    y = (lambda x, s, axes=(-2,-1): torch.fft.irfft2(x, s=s, dim=axes).to(torch.bfloat16))(Yf, (H, W), axes=(1, 2))
    return y
```

```asm
; @launch grid=(252,1,1) block=(256,1,1) lds=156672
.amdgcn_target "amdgcn-amd-amdhsa--gfx950"
.text
.globl standalone__fft_conv__vision_kernel
.p2align 12
.p2align 8
.type standalone__fft_conv__vision_kernel,@function
standalone__fft_conv__vision_kernel:
  s_load_dwordx4 s[4:7], s[0:1], 0
  s_load_dwordx2 s[16:17], s[0:1], 16
  s_cmp_ge_u32 s2, 252
  s_cbranch_scc1 L_end
  v_lshrrev_b32 v1, 6, v0
  v_and_b32 v0, 63, v0
  v_readfirstlane_b32 s22, v1
  s_lshr_b32 s30, s2, 3
  s_and_b32 s31, s2, 7
  s_mul_i32 s32, s30, 86
  s_lshl_b32 s39, s30, 2
  s_lshr_b32 s32, s32, 8
  s_mul_i32 s31, s31, 10
  s_mul_i32 s33, s32, 3
  s_add_u32 s31, s31, s32
  s_sub_u32 s35, s30, s33
  s_cmp_lt_u32 s2, 240
  s_cbranch_scc1 L_map_done
  s_sub_u32 s30, s2, 240
  s_mul_i32 s32, s30, 86
  s_lshr_b32 s32, s32, 8
  s_mul_i32 s33, s32, 3
  s_sub_u32 s35, s30, s33
  s_add_u32 s31, s32, 80
L_map_done:
  s_add_u32 s39, s39, s22
  s_mul_i32 s32, s31, 9363
  s_lshr_b32 s32, s32, 16
  s_mul_i32 s33, s32, 7
  s_sub_u32 s33, s31, s33
  s_mul_i32 s30, s33, 86
  s_lshl_b32 s36, s33, 5
  s_lshr_b32 s30, s30, 8
  s_mul_i32 s30, s30, 3
  s_sub_u32 s30, s33, s30
  s_add_u32 s31, s32, s30
  s_add_u32 s33, s31, 2
  s_mul_i32 s33, s33, 86
  s_lshr_b32 s33, s33, 8
  s_cmp_ge_u32 s30, 1
  s_cselect_b32 s30, 1, 0
  s_sub_u32 s33, s33, s30
  s_mul_i32 s30, s32, 19
  s_sub_u32 s30, s30, s33
  s_mul_i32 s28, s30, 43008
  s_add_u32 s26, s28, 9461760
  s_mov_b32 s50, s28
  s_add_u32 s28, s28, 172032
  s_mul_i32 s41, s31, 86
  s_lshr_b32 s41, s41, 8
  s_mul_i32 s41, s41, 3
  s_cmp_eq_u32 s41, s31
  s_cselect_b32 s49, 0, -1
  s_cselect_b32 s41, 0x40000000, 0
  s_lshl_b32 s40, s22, 6
  v_add_u32 v18, s40, v0
  s_add_u32 s30, s36, 220
  v_mul_u32_u24 v19, 5462, v18
  v_lshrrev_b32 v19, 16, v19
  v_mul_u32_u24 v20, 12, v19
  v_lshrrev_b32 v21, 1, v19
  v_sub_u32 v20, v18, v20
  v_and_b32 v21, 2, v21
  v_add_u32 v19, s30, v19
  v_xor_b32 v20, v20, v21
  v_subrev_u32 v21, 224, v19
  v_min_u32 v19, v19, v21
  v_mul_u32_u24 v19, 192, v19
  v_lshl_add_u32 v12, v20, 4, v19
  v_add_u32 v18, 256, v18
  v_mul_u32_u24 v19, 5462, v18
  v_lshrrev_b32 v19, 16, v19
  v_mul_u32_u24 v20, 12, v19
  v_lshrrev_b32 v21, 1, v19
  v_sub_u32 v20, v18, v20
  v_and_b32 v21, 2, v21
  v_add_u32 v19, s30, v19
  v_xor_b32 v20, v20, v21
  v_subrev_u32 v21, 224, v19
  v_min_u32 v19, v19, v21
  v_cmp_gt_u32 vcc, 432, v18
  v_mul_u32_u24 v19, 192, v19
  v_lshl_add_u32 v13, v20, 4, v19
  v_mov_b32 v19, 0x40000000
  v_cndmask_b32 v13, v19, v13, vcc
  s_lshl_b32 s23, s22, 10
  s_add_u32 s24, s23, 4096
  s_cmp_eq_u32 s22, 3
  s_cselect_b32 s24, 155648, s24
  s_cselect_b32 s25, 0, -1
  s_mov_b32 s10, 9633792
  s_mov_b32 s11, 0x20000
  s_mov_b32 s14, 460800
  s_mov_b32 s15, 0x20000
  v_mov_b32 v23, 0x40000000
  s_mul_i32 s30, s22, 14
  v_add_u32 v18, s30, v0
  v_mul_u32_u24 v19, 3641, v18
  s_mul_i32 s30, s35, 18
  v_lshrrev_b32 v19, 16, v19
  v_mul_u32_u24 v20, 18, v19
  v_sub_u32 v20, v18, v20
  v_add_u32 v20, s30, v20
  s_add_u32 s30, s36, 220
  v_lshlrev_b32 v20, 7, v20
  s_mul_i32 s30, s30, 192
  s_mov_b32 s31, 43008
  v_add_u32 v20, s30, v20
  v_subrev_u32 v21, 43008, v20
  v_min_u32 v20, v20, v21
  v_add_u32 v21, 5, v19
  v_mul_lo_u32 v21, v21, s31
  s_mov_b32 s32, 9633792
  v_cmp_gt_u32 vcc, 54, v18
  v_add_u32 v21, s26, v21
  v_subrev_u32 v19, s32, v21
  v_min_u32 v21, v21, v19
  v_add_u32 v21, v21, v20
  v_cndmask_b32 v21, v23, v21, vcc
  v_cmp_gt_u32 vcc, 14, v0
  s_nop 1
  v_cndmask_b32 v200, v23, v21, vcc
  s_mul_i32 s30, s39, 29
  v_cmp_gt_u32 vcc, 29, v0
  v_add_u32 v18, s30, v0
  v_lshlrev_b32 v18, 7, v18
  v_cndmask_b32 v17, v23, v18, vcc
  s_getpc_b64 s[44:45]
L_pc:
  s_sub_u32 s44, s44, L_pc-standalone__fft_conv__vision_kernel
  s_subb_u32 s45, s45, 0
  s_and_b32 s45, s45, 0xffff
  s_mov_b32 s46, 17792
  s_mov_b32 s47, 0x20000
  v_cmp_gt_u32 vcc, 2, v0
  v_lshlrev_b32 v18, 7, v0
  s_lshl_b32 s48, s39, 8
  v_cndmask_b32 v207, v23, v18, vcc
  s_add_u32 s34, s23, 114688
  s_add_u32 s37, s34, 8192
  s_cmp_ge_u32 s22, 2
  s_cselect_b32 s37, 155648, s37
  s_cselect_b32 s38, 0, -1
  v_lshrrev_b32 v18, 4, v0
  v_bfe_u32 v19, v0, 2, 2
  v_lshl_add_u32 v19, v18, 3, v19
  v_and_b32 v18, 1, v18
  v_mul_u32_u24 v19, 192, v19
  v_lshlrev_b32 v18, 1, v18
  v_and_b32 v20, 3, v0
  s_lshr_b32 s30, s22, 1
  v_xor_b32 v20, v20, v18
  s_mul_i32 s30, s30, 92160
  v_lshl_add_u32 v19, v20, 4, v19
  s_and_b32 s31, s22, 1
  s_mul_i32 s31, s31, 768
  s_add_u32 s30, s30, s31
  s_lshl_b32 s31, s35, 6
  s_add_u32 s30, s30, s31
  v_add_u32 v14, s30, v19
  s_waitcnt lgkmcnt(0)
  s_mov_b32 s8, s4
  s_mov_b32 s9, s5
  s_mov_b32 s12, s6
  s_mov_b32 s13, s7
  buffer_load_dword v203, v17, s[12:15], 0 offen
  buffer_load_dword v202, v200, s[8:11], 0 offen
  buffer_load_dword v205, v207, s[44:47], s48 offen
  s_add_u32 s30, s26, 172032
  s_sub_u32 s31, s30, 9633792
  s_min_u32 s27, s30, s31
  s_add_u32 m0, s23, 28672
  s_nop 0
  buffer_load_dwordx4 v12, s[8:11], s27 offen lds
  s_and_b32 s32, s25, 28672
  s_add_u32 m0, s24, s32
  s_nop 0
  buffer_load_dwordx4 v13, s[8:11], s27 offen lds
  s_mov_b32 s33, 0
  s_add_u32 m0, s34, 0
  s_nop 0
  buffer_load_dwordx4 v14, s[12:15], s33 offen lds
  s_mov_b32 s33, 184320
  s_add_u32 m0, s34, 4096
  s_nop 0
  buffer_load_dwordx4 v14, s[12:15], s33 offen lds
  s_mov_b32 s33, 368640
  s_mov_b32 m0, s37
  s_nop 0
  buffer_load_dwordx4 v14, s[12:15], s33 offen lds
  s_add_u32 s30, s26, 215040
  s_sub_u32 s31, s30, 9633792
  s_min_u32 s27, s30, s31
  s_add_u32 m0, s23, 35840
  s_nop 0
  buffer_load_dwordx4 v12, s[8:11], s27 offen lds
  s_and_b32 s32, s25, 35840
  s_add_u32 m0, s24, s32
  s_nop 0
  buffer_load_dwordx4 v13, s[8:11], s27 offen lds
  s_add_u32 s30, s26, 258048
  s_sub_u32 s31, s30, 9633792
  s_min_u32 s27, s30, s31
  s_add_u32 m0, s23, 43008
  s_nop 0
  buffer_load_dwordx4 v12, s[8:11], s27 offen lds
  s_and_b32 s32, s25, 43008
  s_add_u32 m0, s24, s32
  s_nop 0
  buffer_load_dwordx4 v13, s[8:11], s27 offen lds
  s_add_u32 s30, s26, 301056
  s_sub_u32 s31, s30, 9633792
  s_min_u32 s27, s30, s31
  s_add_u32 m0, s23, 50176
  s_nop 0
  buffer_load_dwordx4 v12, s[8:11], s27 offen lds
  s_and_b32 s32, s25, 50176
  s_add_u32 m0, s24, s32
  s_nop 0
  buffer_load_dwordx4 v13, s[8:11], s27 offen lds
  s_mov_b32 s33, 6144
  s_add_u32 m0, s34, 10240
  s_nop 0
  buffer_load_dwordx4 v14, s[12:15], s33 offen lds
  s_mov_b32 s33, 190464
  s_add_u32 m0, s34, 14336
  s_nop 0
  buffer_load_dwordx4 v14, s[12:15], s33 offen lds
  s_mov_b32 s33, 374784
  s_and_b32 s39, s38, 10240
  s_add_u32 m0, s37, s39
  s_nop 0
  buffer_load_dwordx4 v14, s[12:15], s33 offen lds
  s_mov_b32 s18, 9633792
  s_mov_b32 s19, 0x20000
  v_and_b32 v18, 15, v0
  v_lshrrev_b32 v19, 4, v0
  s_lshr_b32 s30, s22, 1
  s_lshl_b32 s30, s30, 4
  v_add_u32 v22, s30, v18
  v_add_u32 v20, 4, v22
  v_lshrrev_b32 v21, 1, v20
  v_and_b32 v21, 2, v21
  v_xor_b32 v21, v21, v19
  v_mul_u32_u24 v20, 192, v20
  v_lshl_add_u32 v2, v21, 4, v20
  v_add_u32 v7, 71680, v2
  v_add_u32 v20, 3, v22
  v_lshrrev_b32 v21, 1, v20
  v_and_b32 v21, 2, v21
  v_xor_b32 v21, v21, v19
  v_mul_u32_u24 v20, 192, v20
  v_lshl_add_u32 v3, v21, 4, v20
  v_add_u32 v8, 71680, v3
  v_add_u32 v20, 2, v22
  v_lshrrev_b32 v21, 1, v20
  v_and_b32 v21, 2, v21
  v_xor_b32 v21, v21, v19
  v_mul_u32_u24 v20, 192, v20
  v_lshl_add_u32 v4, v21, 4, v20
  v_add_u32 v9, 71680, v4
  v_add_u32 v20, 1, v22
  v_lshrrev_b32 v21, 1, v20
  v_and_b32 v21, 2, v21
  v_xor_b32 v21, v21, v19
  v_mul_u32_u24 v20, 192, v20
  v_lshl_add_u32 v5, v21, 4, v20
  v_add_u32 v10, 71680, v5
  v_add_u32 v20, 0, v22
  v_lshrrev_b32 v21, 1, v20
  v_and_b32 v21, 2, v21
  v_xor_b32 v21, v21, v19
  v_mul_u32_u24 v20, 192, v20
  v_lshl_add_u32 v6, v21, 4, v20
  v_add_u32 v11, 71680, v6
  s_and_b32 s31, s22, 1
  v_and_b32 v20, 1, v19
  v_xor_b32 v20, s31, v20
  v_lshlrev_b32 v20, 5, v20
  v_lshrrev_b32 v21, 2, v0
  v_lshl_add_u32 v20, v21, 6, v20
  v_and_b32 v21, 3, v0
  v_lshl_add_u32 v20, v21, 3, v20
  v_add_u32 v15, 114688, v20
  v_add_u32 v20, s36, v22
  v_mul_u32_u24 v20, 192, v20
  v_lshl_add_u32 v20, v19, 3, v20
  s_lshl_b32 s30, s35, 1
  s_add_u32 s30, s30, s31
  s_lshl_b32 s30, s30, 5
  v_add_u32 v16, s30, v20
  s_waitcnt vmcnt(9)
  s_barrier
  s_mov_b32 s33, 12288
  s_add_u32 m0, s34, 20480
  s_nop 0
  buffer_load_dwordx4 v14, s[12:15], s33 offen lds
  s_mov_b32 s33, 196608
  s_add_u32 m0, s34, 24576
  s_nop 0
  buffer_load_dwordx4 v14, s[12:15], s33 offen lds
  s_mov_b32 s33, 380928
  s_and_b32 s39, s38, 20480
  s_add_u32 m0, s37, s39
  s_nop 0
  buffer_load_dwordx4 v14, s[12:15], s33 offen lds
  s_waitcnt vmcnt(6)
  s_barrier
  ds_read_b64_tr_b16 a[0:1], v15 offset:0
  ds_read_b64_tr_b16 a[2:3], v15 offset:1024
  ds_read_b128 v[108:111], v2 offset:28672
  ds_read_b64_tr_b16 a[60:61], v15 offset:2048
  ds_read_b64_tr_b16 a[62:63], v15 offset:3072
  ds_read_b64_tr_b16 a[120:121], v15 offset:4096
  ds_read_b64_tr_b16 a[122:123], v15 offset:5120
  ds_read_b64_tr_b16 a[180:181], v15 offset:6144
  ds_read_b64_tr_b16 a[182:183], v15 offset:7168
  ds_read_b64_tr_b16 a[240:241], v15 offset:8192
  ds_read_b64_tr_b16 a[242:243], v15 offset:9216
  ds_read_b128 v[112:115], v2 offset:50176
  ds_read_b128 v[116:119], v2 offset:43008
  s_waitcnt lgkmcnt(10)
  v_mfma_f32_16x16x32_bf16 v[168:171], a[0:3], v[108:111], 0
  ds_read_b128 v[120:123], v2 offset:35840
  s_mov_b32 s33, 18432
  s_add_u32 m0, s34, 30720
  s_nop 0
  buffer_load_dwordx4 v14, s[12:15], s33 offen lds
  s_waitcnt lgkmcnt(9)
  v_mfma_f32_16x16x32_bf16 v[172:175], a[60:63], v[108:111], 0
  s_mov_b32 s33, 202752
  s_add_u32 m0, s34, 34816
  s_nop 0
  buffer_load_dwordx4 v14, s[12:15], s33 offen lds
  s_mov_b32 s33, 387072
  s_waitcnt lgkmcnt(7)
  v_mfma_f32_16x16x32_bf16 v[176:179], a[120:123], v[108:111], 0
  s_and_b32 s39, s38, 30720
  s_add_u32 m0, s37, s39
  s_nop 0
  buffer_load_dwordx4 v14, s[12:15], s33 offen lds
  s_waitcnt lgkmcnt(5)
  v_mfma_f32_16x16x32_bf16 v[180:183], a[180:183], v[108:111], 0
  s_waitcnt lgkmcnt(3)
  v_mfma_f32_16x16x32_bf16 v[184:187], a[240:243], v[108:111], 0
  s_waitcnt lgkmcnt(1)
  v_mfma_f32_16x16x32_bf16 v[196:199], a[240:243], v[112:115], 0
  v_mfma_f32_16x16x32_bf16 v[192:195], a[180:183], v[112:115], 0
  v_mfma_f32_16x16x32_bf16 v[192:195], a[240:243], v[116:119], v[192:195]
  v_mfma_f32_16x16x32_bf16 v[188:191], a[120:123], v[112:115], 0
  ds_read_b128 v[124:127], v2 offset:28736
  v_mfma_f32_16x16x32_bf16 v[188:191], a[180:183], v[116:119], v[188:191]
  s_waitcnt lgkmcnt(1)
  v_mfma_f32_16x16x32_bf16 v[188:191], a[240:243], v[120:123], v[188:191]
  ds_read_b128 v[128:131], v2 offset:35904
  v_mfma_f32_16x16x32_bf16 v[184:187], a[60:63], v[112:115], v[184:187]
  s_waitcnt vmcnt(6)
  s_barrier
  v_mfma_f32_16x16x32_bf16 v[184:187], a[120:123], v[116:119], v[184:187]
  ds_read_b64_tr_b16 a[4:5], v15 offset:10240
  s_mov_b32 s33, 24576
  ds_read_b64_tr_b16 a[6:7], v15 offset:11264
  s_add_u32 m0, s34, 0
  v_mfma_f32_16x16x32_bf16 v[184:187], a[180:183], v[120:123], v[184:187]
  ds_read_b64_tr_b16 a[64:65], v15 offset:12288
  buffer_load_dwordx4 v14, s[12:15], s33 offen lds
  ds_read_b64_tr_b16 a[66:67], v15 offset:13312
  s_mov_b32 s33, 208896
  v_mfma_f32_16x16x32_bf16 v[180:183], a[0:3], v[112:115], v[180:183]
  ds_read_b64_tr_b16 a[124:125], v15 offset:14336
  s_add_u32 m0, s34, 4096
  ds_read_b64_tr_b16 a[126:127], v15 offset:15360
  buffer_load_dwordx4 v14, s[12:15], s33 offen lds
  v_mfma_f32_16x16x32_bf16 v[180:183], a[60:63], v[116:119], v[180:183]
  ds_read_b128 v[132:135], v2 offset:43072
  s_mov_b32 s33, 393216
  ds_read_b64_tr_b16 a[184:185], v15 offset:16384
  s_mov_b32 m0, s37
  v_mfma_f32_16x16x32_bf16 v[180:183], a[120:123], v[120:123], v[180:183]
  ds_read_b64_tr_b16 a[186:187], v15 offset:17408
  buffer_load_dwordx4 v14, s[12:15], s33 offen lds
  ds_read_b64_tr_b16 a[244:245], v15 offset:18432
  ds_read_b64_tr_b16 a[246:247], v15 offset:19456
  v_mfma_f32_16x16x32_bf16 v[176:179], a[0:3], v[116:119], v[176:179]
  ds_read_b128 v[136:139], v2 offset:50240
  v_mfma_f32_16x16x32_bf16 v[176:179], a[60:63], v[120:123], v[176:179]
  v_mfma_f32_16x16x32_bf16 v[172:175], a[0:3], v[120:123], v[172:175]
  s_waitcnt lgkmcnt(6)
  v_mfma_f32_16x16x32_bf16 v[168:171], a[4:7], v[124:127], v[168:171]
  v_mfma_f32_16x16x32_bf16 v[172:175], a[64:67], v[124:127], v[172:175]
  v_mfma_f32_16x16x32_bf16 v[172:175], a[4:7], v[128:131], v[172:175]
  v_mfma_f32_16x16x32_bf16 v[176:179], a[124:127], v[124:127], v[176:179]
  v_mfma_f32_16x16x32_bf16 v[176:179], a[64:67], v[128:131], v[176:179]
  s_waitcnt lgkmcnt(0)
  v_mfma_f32_16x16x32_bf16 v[176:179], a[4:7], v[132:135], v[176:179]
  v_mfma_f32_16x16x32_bf16 v[180:183], a[184:187], v[124:127], v[180:183]
  v_mfma_f32_16x16x32_bf16 v[180:183], a[124:127], v[128:131], v[180:183]
  v_mfma_f32_16x16x32_bf16 v[180:183], a[64:67], v[132:135], v[180:183]
  ds_read_b128 v[140:143], v2 offset:50304
  v_mfma_f32_16x16x32_bf16 v[180:183], a[4:7], v[136:139], v[180:183]
  v_mfma_f32_16x16x32_bf16 v[184:187], a[244:247], v[124:127], v[184:187]
  ds_read_b128 v[144:147], v2 offset:43136
  v_mfma_f32_16x16x32_bf16 v[184:187], a[184:187], v[128:131], v[184:187]
  s_waitcnt vmcnt(6)
  s_barrier
  v_mfma_f32_16x16x32_bf16 v[184:187], a[124:127], v[132:135], v[184:187]
  ds_read_b64_tr_b16 a[248:249], v15 offset:28672
  s_mov_b32 s33, 30720
  v_mfma_f32_16x16x32_bf16 v[184:187], a[64:67], v[136:139], v[184:187]
  ds_read_b64_tr_b16 a[250:251], v15 offset:29696
  s_add_u32 m0, s34, 10240
  v_mfma_f32_16x16x32_bf16 v[188:191], a[244:247], v[128:131], v[188:191]
  ds_read_b64_tr_b16 a[188:189], v15 offset:26624
  buffer_load_dwordx4 v14, s[12:15], s33 offen lds
  v_mfma_f32_16x16x32_bf16 v[188:191], a[184:187], v[132:135], v[188:191]
  ds_read_b64_tr_b16 a[190:191], v15 offset:27648
  s_mov_b32 s33, 215040
  v_mfma_f32_16x16x32_bf16 v[188:191], a[124:127], v[136:139], v[188:191]
  ds_read_b64_tr_b16 a[128:129], v15 offset:24576
  s_add_u32 m0, s34, 14336
  v_mfma_f32_16x16x32_bf16 v[192:195], a[244:247], v[132:135], v[192:195]
  ds_read_b64_tr_b16 a[130:131], v15 offset:25600
  buffer_load_dwordx4 v14, s[12:15], s33 offen lds
  v_mfma_f32_16x16x32_bf16 v[192:195], a[184:187], v[136:139], v[192:195]
  ds_read_b128 v[148:151], v2 offset:35968
  s_mov_b32 s33, 399360
  v_mfma_f32_16x16x32_bf16 v[196:199], a[244:247], v[136:139], v[196:199]
  ds_read_b64_tr_b16 a[68:69], v15 offset:22528
  s_and_b32 s39, s38, 10240
  s_waitcnt lgkmcnt(5)
  v_mfma_f32_16x16x32_bf16 v[196:199], a[248:251], v[140:143], v[196:199]
  ds_read_b64_tr_b16 a[70:71], v15 offset:23552
  s_add_u32 m0, s37, s39
  s_waitcnt lgkmcnt(5)
  v_mfma_f32_16x16x32_bf16 v[192:195], a[188:191], v[140:143], v[192:195]
  ds_read_b128 v[152:155], v2 offset:28800
  buffer_load_dwordx4 v14, s[12:15], s33 offen lds
  s_waitcnt vmcnt(6)
  v_mfma_f32_16x16x32_bf16 v[192:195], a[248:251], v[144:147], v[192:195]
  ds_read_b64_tr_b16 a[8:9], v15 offset:20480
  ds_read_b64_tr_b16 a[10:11], v15 offset:21504
  s_waitcnt lgkmcnt(0)
  v_mfma_f32_16x16x32_bf16 v[188:191], a[128:131], v[140:143], v[188:191]
  s_barrier
  v_mfma_f32_16x16x32_bf16 v[188:191], a[188:191], v[144:147], v[188:191]
  ds_read_b64_tr_b16 a[12:13], v15 offset:30720
  s_mov_b32 s33, 36864
  v_mfma_f32_16x16x32_bf16 v[188:191], a[248:251], v[148:151], v[188:191]
  ds_read_b64_tr_b16 a[14:15], v15 offset:31744
  s_add_u32 m0, s34, 20480
  v_mfma_f32_16x16x32_bf16 v[184:187], a[68:71], v[140:143], v[184:187]
  ds_read_b64_tr_b16 a[72:73], v15 offset:32768
  ds_read_b64_tr_b16 a[74:75], v15 offset:33792
  v_mfma_f32_16x16x32_bf16 v[184:187], a[128:131], v[144:147], v[184:187]
  ds_read_b64_tr_b16 a[132:133], v15 offset:34816
  buffer_load_dwordx4 v14, s[12:15], s33 offen lds
  v_mfma_f32_16x16x32_bf16 v[184:187], a[188:191], v[148:151], v[184:187]
  ds_read_b128 v[156:159], v3 offset:28672
  s_mov_b32 s33, 221184
  v_mfma_f32_16x16x32_bf16 v[184:187], a[248:251], v[152:155], v[184:187]
  ds_read_b64_tr_b16 a[134:135], v15 offset:35840
  ds_read_b64_tr_b16 a[192:193], v15 offset:36864
  v_mfma_f32_16x16x32_bf16 v[180:183], a[8:11], v[140:143], v[180:183]
  ds_read_b128 v[160:163], v3 offset:35840
  s_add_u32 m0, s34, 24576
  v_mfma_f32_16x16x32_bf16 v[180:183], a[68:71], v[144:147], v[180:183]
  ds_read_b64_tr_b16 a[194:195], v15 offset:37888
  buffer_load_dwordx4 v14, s[12:15], s33 offen lds
  v_mfma_f32_16x16x32_bf16 v[180:183], a[128:131], v[148:151], v[180:183]
  ds_read_b64_tr_b16 a[252:253], v15 offset:38912
  ds_read_b64_tr_b16 a[254:255], v15 offset:39936
  v_mfma_f32_16x16x32_bf16 v[180:183], a[188:191], v[152:155], v[180:183]
  ds_read_b128 v[164:167], v3 offset:43008
  s_mov_b32 s33, 405504
  v_mfma_f32_16x16x32_bf16 v[176:179], a[8:11], v[144:147], v[176:179]
  s_and_b32 s39, s38, 20480
  v_mfma_f32_16x16x32_bf16 v[176:179], a[68:71], v[148:151], v[176:179]
  v_mfma_f32_16x16x32_bf16 v[176:179], a[128:131], v[152:155], v[176:179]
  s_add_u32 m0, s37, s39
  v_mfma_f32_16x16x32_bf16 v[172:175], a[8:11], v[148:151], v[172:175]
  ds_read_b128 v[108:111], v3 offset:50176
  buffer_load_dwordx4 v14, s[12:15], s33 offen lds
  v_mfma_f32_16x16x32_bf16 v[172:175], a[68:71], v[152:155], v[172:175]
  v_mfma_f32_16x16x32_bf16 v[168:171], a[8:11], v[152:155], v[168:171]
  s_waitcnt lgkmcnt(1)
  v_mfma_f32_16x16x32_bf16 v[168:171], a[12:15], v[156:159], v[168:171]
  v_mfma_f32_16x16x32_bf16 v[172:175], a[72:75], v[156:159], v[172:175]
  s_waitcnt vmcnt(6)
  v_mfma_f32_16x16x32_bf16 v[172:175], a[12:15], v[160:163], v[172:175]
  v_mfma_f32_16x16x32_bf16 v[176:179], a[132:135], v[156:159], v[176:179]
  s_barrier
  v_mfma_f32_16x16x32_bf16 v[176:179], a[72:75], v[160:163], v[176:179]
  ds_read_b64_tr_b16 v[212:213], v15 offset:8192
  s_mov_b32 s33, 43008
  v_mfma_f32_16x16x32_bf16 v[176:179], a[12:15], v[164:167], v[176:179]
  ds_read_b64_tr_b16 v[214:215], v15 offset:9216
  s_add_u32 m0, s34, 30720
  v_mfma_f32_16x16x32_bf16 v[180:183], a[192:195], v[156:159], v[180:183]
  ds_read_b64_tr_b16 a[196:197], v15 offset:6144
  ds_read_b64_tr_b16 a[198:199], v15 offset:7168
  v_mfma_f32_16x16x32_bf16 v[180:183], a[132:135], v[160:163], v[180:183]
  ds_read_b64_tr_b16 a[136:137], v15 offset:4096
  buffer_load_dwordx4 v14, s[12:15], s33 offen lds
  v_mfma_f32_16x16x32_bf16 v[180:183], a[72:75], v[164:167], v[180:183]
  ds_read_b128 v[112:115], v3 offset:50240
  s_mov_b32 s33, 227328
  s_waitcnt lgkmcnt(6)
  v_mfma_f32_16x16x32_bf16 v[180:183], a[12:15], v[108:111], v[180:183]
  ds_read_b64_tr_b16 a[138:139], v15 offset:5120
  ds_read_b64_tr_b16 a[76:77], v15 offset:2048
  v_mfma_f32_16x16x32_bf16 v[184:187], a[252:255], v[156:159], v[184:187]
  ds_read_b128 v[116:119], v3 offset:43072
  s_add_u32 m0, s34, 34816
  v_mfma_f32_16x16x32_bf16 v[184:187], a[192:195], v[160:163], v[184:187]
  ds_read_b64_tr_b16 a[78:79], v15 offset:3072
  buffer_load_dwordx4 v14, s[12:15], s33 offen lds
  v_mfma_f32_16x16x32_bf16 v[184:187], a[132:135], v[164:167], v[184:187]
  ds_read_b64_tr_b16 a[16:17], v15 offset:0
  ds_read_b64_tr_b16 a[18:19], v15 offset:1024
  v_mfma_f32_16x16x32_bf16 v[184:187], a[72:75], v[108:111], v[184:187]
  ds_read_b128 v[120:123], v3 offset:35904
  s_mov_b32 s33, 411648
  v_mfma_f32_16x16x32_bf16 v[188:191], a[252:255], v[160:163], v[188:191]
  s_and_b32 s39, s38, 30720
  v_mfma_f32_16x16x32_bf16 v[188:191], a[192:195], v[164:167], v[188:191]
  v_mfma_f32_16x16x32_bf16 v[188:191], a[132:135], v[108:111], v[188:191]
  s_add_u32 m0, s37, s39
  v_mfma_f32_16x16x32_bf16 v[192:195], a[252:255], v[164:167], v[192:195]
  ds_read_b128 v[124:127], v3 offset:28736
  buffer_load_dwordx4 v14, s[12:15], s33 offen lds
  v_mfma_f32_16x16x32_bf16 v[192:195], a[192:195], v[108:111], v[192:195]
  v_mfma_f32_16x16x32_bf16 v[196:199], a[252:255], v[108:111], v[196:199]
  s_waitcnt lgkmcnt(1)
  v_mfma_f32_16x16x32_bf16 v[196:199], v[212:215], v[112:115], v[196:199]
  v_mfma_f32_16x16x32_bf16 v[192:195], a[196:199], v[112:115], v[192:195]
  s_waitcnt vmcnt(6)
  v_mfma_f32_16x16x32_bf16 v[192:195], v[212:215], v[116:119], v[192:195]
  v_mfma_f32_16x16x32_bf16 v[188:191], a[136:139], v[112:115], v[188:191]
  s_barrier
  v_mfma_f32_16x16x32_bf16 v[188:191], a[196:199], v[116:119], v[188:191]
  ds_read_b64_tr_b16 a[20:21], v15 offset:10240
  s_mov_b32 s33, 49152
  v_mfma_f32_16x16x32_bf16 v[188:191], v[212:215], v[120:123], v[188:191]
  ds_read_b64_tr_b16 a[22:23], v15 offset:11264
  s_add_u32 m0, s34, 0
  v_mfma_f32_16x16x32_bf16 v[184:187], a[76:79], v[112:115], v[184:187]
  ds_read_b64_tr_b16 a[80:81], v15 offset:12288
  ds_read_b64_tr_b16 a[82:83], v15 offset:13312
  v_mfma_f32_16x16x32_bf16 v[184:187], a[136:139], v[116:119], v[184:187]
  ds_read_b64_tr_b16 a[140:141], v15 offset:14336
  buffer_load_dwordx4 v14, s[12:15], s33 offen lds
  v_mfma_f32_16x16x32_bf16 v[184:187], a[196:199], v[120:123], v[184:187]
  ds_read_b128 v[128:131], v3 offset:28800
  ds_read_b64_tr_b16 a[142:143], v15 offset:15360
  s_waitcnt lgkmcnt(7)
  v_mfma_f32_16x16x32_bf16 v[184:187], v[212:215], v[124:127], v[184:187]
  ds_read_b64_tr_b16 a[200:201], v15 offset:16384
  s_mov_b32 s33, 233472
  v_mfma_f32_16x16x32_bf16 v[180:183], a[16:19], v[112:115], v[180:183]
  ds_read_b128 v[132:135], v3 offset:35968
  ds_read_b64_tr_b16 a[202:203], v15 offset:17408
  v_mfma_f32_16x16x32_bf16 v[180:183], a[76:79], v[116:119], v[180:183]
  ds_read_b64_tr_b16 v[216:217], v15 offset:18432
  s_add_u32 m0, s34, 4096
  v_mfma_f32_16x16x32_bf16 v[180:183], a[136:139], v[120:123], v[180:183]
  ds_read_b64_tr_b16 v[218:219], v15 offset:19456
  buffer_load_dwordx4 v14, s[12:15], s33 offen lds
  v_mfma_f32_16x16x32_bf16 v[180:183], a[196:199], v[124:127], v[180:183]
  ds_read_b128 v[136:139], v3 offset:43136
  v_mfma_f32_16x16x32_bf16 v[176:179], a[16:19], v[116:119], v[176:179]
  s_mov_b32 s33, 417792
  v_mfma_f32_16x16x32_bf16 v[176:179], a[76:79], v[120:123], v[176:179]
  v_mfma_f32_16x16x32_bf16 v[176:179], a[136:139], v[124:127], v[176:179]
  s_mov_b32 m0, s37
  v_mfma_f32_16x16x32_bf16 v[172:175], a[16:19], v[120:123], v[172:175]
  ds_read_b128 v[140:143], v3 offset:50304
  v_mfma_f32_16x16x32_bf16 v[172:175], a[76:79], v[124:127], v[172:175]
  buffer_load_dwordx4 v14, s[12:15], s33 offen lds
  v_mfma_f32_16x16x32_bf16 v[168:171], a[16:19], v[124:127], v[168:171]
  s_waitcnt lgkmcnt(1)
  v_mfma_f32_16x16x32_bf16 v[168:171], a[20:23], v[128:131], v[168:171]
  v_mfma_f32_16x16x32_bf16 v[172:175], a[80:83], v[128:131], v[172:175]
  s_waitcnt vmcnt(6)
  v_mfma_f32_16x16x32_bf16 v[172:175], a[20:23], v[132:135], v[172:175]
  v_mfma_f32_16x16x32_bf16 v[176:179], a[140:143], v[128:131], v[176:179]
  s_barrier
  v_mfma_f32_16x16x32_bf16 v[176:179], a[80:83], v[132:135], v[176:179]
  ds_read_b64_tr_b16 v[220:221], v15 offset:28672
  s_mov_b32 s33, 55296
  v_mfma_f32_16x16x32_bf16 v[176:179], a[20:23], v[136:139], v[176:179]
  ds_read_b64_tr_b16 v[222:223], v15 offset:29696
  s_add_u32 m0, s34, 10240
  v_mfma_f32_16x16x32_bf16 v[180:183], a[200:203], v[128:131], v[180:183]
  ds_read_b64_tr_b16 a[204:205], v15 offset:26624
  ds_read_b64_tr_b16 a[206:207], v15 offset:27648
  v_mfma_f32_16x16x32_bf16 v[180:183], a[140:143], v[132:135], v[180:183]
  ds_read_b64_tr_b16 a[144:145], v15 offset:24576
  buffer_load_dwordx4 v14, s[12:15], s33 offen lds
  v_mfma_f32_16x16x32_bf16 v[180:183], a[80:83], v[136:139], v[180:183]
  ds_read_b128 v[144:147], v4 offset:50176
  s_mov_b32 s33, 239616
  s_waitcnt lgkmcnt(6)
  v_mfma_f32_16x16x32_bf16 v[180:183], a[20:23], v[140:143], v[180:183]
  ds_read_b64_tr_b16 a[146:147], v15 offset:25600
  ds_read_b64_tr_b16 a[84:85], v15 offset:22528
  v_mfma_f32_16x16x32_bf16 v[184:187], v[216:219], v[128:131], v[184:187]
  ds_read_b128 v[148:151], v4 offset:43008
  s_add_u32 m0, s34, 14336
  v_mfma_f32_16x16x32_bf16 v[184:187], a[200:203], v[132:135], v[184:187]
  ds_read_b64_tr_b16 a[86:87], v15 offset:23552
  buffer_load_dwordx4 v14, s[12:15], s33 offen lds
  v_mfma_f32_16x16x32_bf16 v[184:187], a[140:143], v[136:139], v[184:187]
  ds_read_b64_tr_b16 a[24:25], v15 offset:20480
  ds_read_b64_tr_b16 a[26:27], v15 offset:21504
  v_mfma_f32_16x16x32_bf16 v[184:187], a[80:83], v[140:143], v[184:187]
  ds_read_b128 v[152:155], v4 offset:35840
  s_mov_b32 s33, 423936
  v_mfma_f32_16x16x32_bf16 v[188:191], v[216:219], v[132:135], v[188:191]
  s_and_b32 s39, s38, 10240
  v_mfma_f32_16x16x32_bf16 v[188:191], a[200:203], v[136:139], v[188:191]
  v_mfma_f32_16x16x32_bf16 v[188:191], a[140:143], v[140:143], v[188:191]
  s_add_u32 m0, s37, s39
  v_mfma_f32_16x16x32_bf16 v[192:195], v[216:219], v[136:139], v[192:195]
  ds_read_b128 v[156:159], v4 offset:28672
  buffer_load_dwordx4 v14, s[12:15], s33 offen lds
  v_mfma_f32_16x16x32_bf16 v[192:195], a[200:203], v[140:143], v[192:195]
  v_mfma_f32_16x16x32_bf16 v[196:199], v[216:219], v[140:143], v[196:199]
  s_waitcnt lgkmcnt(1)
  v_mfma_f32_16x16x32_bf16 v[196:199], v[220:223], v[144:147], v[196:199]
  v_mfma_f32_16x16x32_bf16 v[192:195], a[204:207], v[144:147], v[192:195]
  s_waitcnt vmcnt(6)
  v_mfma_f32_16x16x32_bf16 v[192:195], v[220:223], v[148:151], v[192:195]
  v_mfma_f32_16x16x32_bf16 v[188:191], a[144:147], v[144:147], v[188:191]
  s_barrier
  v_mfma_f32_16x16x32_bf16 v[188:191], a[204:207], v[148:151], v[188:191]
  ds_read_b64_tr_b16 a[28:29], v15 offset:30720
  s_mov_b32 s33, 61440
  v_mfma_f32_16x16x32_bf16 v[188:191], v[220:223], v[152:155], v[188:191]
  ds_read_b64_tr_b16 a[30:31], v15 offset:31744
  s_add_u32 m0, s34, 20480
  v_mfma_f32_16x16x32_bf16 v[184:187], a[84:87], v[144:147], v[184:187]
  ds_read_b64_tr_b16 a[88:89], v15 offset:32768
  ds_read_b64_tr_b16 a[90:91], v15 offset:33792
  v_mfma_f32_16x16x32_bf16 v[184:187], a[144:147], v[148:151], v[184:187]
  ds_read_b64_tr_b16 a[148:149], v15 offset:34816
  buffer_load_dwordx4 v14, s[12:15], s33 offen lds
  v_mfma_f32_16x16x32_bf16 v[184:187], a[204:207], v[152:155], v[184:187]
  ds_read_b128 v[160:163], v4 offset:28736
  s_mov_b32 s33, 245760
  s_waitcnt lgkmcnt(6)
  v_mfma_f32_16x16x32_bf16 v[184:187], v[220:223], v[156:159], v[184:187]
  ds_read_b64_tr_b16 a[150:151], v15 offset:35840
  ds_read_b64_tr_b16 a[208:209], v15 offset:36864
  v_mfma_f32_16x16x32_bf16 v[180:183], a[24:27], v[144:147], v[180:183]
  ds_read_b128 v[164:167], v4 offset:35904
  s_add_u32 m0, s34, 24576
  v_mfma_f32_16x16x32_bf16 v[180:183], a[84:87], v[148:151], v[180:183]
  ds_read_b64_tr_b16 a[210:211], v15 offset:37888
  buffer_load_dwordx4 v14, s[12:15], s33 offen lds
  v_mfma_f32_16x16x32_bf16 v[180:183], a[144:147], v[152:155], v[180:183]
  ds_read_b64_tr_b16 v[224:225], v15 offset:38912
  ds_read_b64_tr_b16 v[226:227], v15 offset:39936
  v_mfma_f32_16x16x32_bf16 v[180:183], a[204:207], v[156:159], v[180:183]
  ds_read_b128 v[108:111], v4 offset:43072
  s_mov_b32 s33, 430080
  v_mfma_f32_16x16x32_bf16 v[176:179], a[24:27], v[148:151], v[176:179]
  s_and_b32 s39, s38, 20480
  v_mfma_f32_16x16x32_bf16 v[176:179], a[84:87], v[152:155], v[176:179]
  v_mfma_f32_16x16x32_bf16 v[176:179], a[144:147], v[156:159], v[176:179]
  s_add_u32 m0, s37, s39
  v_mfma_f32_16x16x32_bf16 v[172:175], a[24:27], v[152:155], v[172:175]
  ds_read_b128 v[112:115], v4 offset:50240
  buffer_load_dwordx4 v14, s[12:15], s33 offen lds
  v_mfma_f32_16x16x32_bf16 v[172:175], a[84:87], v[156:159], v[172:175]
  v_mfma_f32_16x16x32_bf16 v[168:171], a[24:27], v[156:159], v[168:171]
  s_waitcnt lgkmcnt(1)
  v_mfma_f32_16x16x32_bf16 v[168:171], a[28:31], v[160:163], v[168:171]
  v_mfma_f32_16x16x32_bf16 v[172:175], a[88:91], v[160:163], v[172:175]
  s_waitcnt vmcnt(6)
  v_mfma_f32_16x16x32_bf16 v[172:175], a[28:31], v[164:167], v[172:175]
  v_mfma_f32_16x16x32_bf16 v[176:179], a[148:151], v[160:163], v[176:179]
  s_barrier
  v_mfma_f32_16x16x32_bf16 v[176:179], a[88:91], v[164:167], v[176:179]
  ds_read_b64_tr_b16 v[228:229], v15 offset:8192
  s_mov_b32 s33, 67584
  v_mfma_f32_16x16x32_bf16 v[176:179], a[28:31], v[108:111], v[176:179]
  ds_read_b64_tr_b16 v[230:231], v15 offset:9216
  s_add_u32 m0, s34, 30720
  v_mfma_f32_16x16x32_bf16 v[180:183], a[208:211], v[160:163], v[180:183]
  ds_read_b64_tr_b16 a[212:213], v15 offset:6144
  ds_read_b64_tr_b16 a[214:215], v15 offset:7168
  v_mfma_f32_16x16x32_bf16 v[180:183], a[148:151], v[164:167], v[180:183]
  ds_read_b64_tr_b16 a[152:153], v15 offset:4096
  buffer_load_dwordx4 v14, s[12:15], s33 offen lds
  v_mfma_f32_16x16x32_bf16 v[180:183], a[88:91], v[108:111], v[180:183]
  ds_read_b128 v[116:119], v4 offset:50304
  s_mov_b32 s33, 251904
  s_waitcnt lgkmcnt(6)
  v_mfma_f32_16x16x32_bf16 v[180:183], a[28:31], v[112:115], v[180:183]
  ds_read_b64_tr_b16 a[154:155], v15 offset:5120
  ds_read_b64_tr_b16 a[92:93], v15 offset:2048
  v_mfma_f32_16x16x32_bf16 v[184:187], v[224:227], v[160:163], v[184:187]
  ds_read_b128 v[120:123], v4 offset:43136
  s_add_u32 m0, s34, 34816
  v_mfma_f32_16x16x32_bf16 v[184:187], a[208:211], v[164:167], v[184:187]
  ds_read_b64_tr_b16 a[94:95], v15 offset:3072
  buffer_load_dwordx4 v14, s[12:15], s33 offen lds
  v_mfma_f32_16x16x32_bf16 v[184:187], a[148:151], v[108:111], v[184:187]
  ds_read_b64_tr_b16 a[32:33], v15 offset:0
  ds_read_b64_tr_b16 a[34:35], v15 offset:1024
  v_mfma_f32_16x16x32_bf16 v[184:187], a[88:91], v[112:115], v[184:187]
  ds_read_b128 v[124:127], v4 offset:35968
  s_mov_b32 s33, 436224
  v_mfma_f32_16x16x32_bf16 v[188:191], v[224:227], v[164:167], v[188:191]
  s_and_b32 s39, s38, 30720
  v_mfma_f32_16x16x32_bf16 v[188:191], a[208:211], v[108:111], v[188:191]
  v_mfma_f32_16x16x32_bf16 v[188:191], a[148:151], v[112:115], v[188:191]
  s_add_u32 m0, s37, s39
  v_mfma_f32_16x16x32_bf16 v[192:195], v[224:227], v[108:111], v[192:195]
  ds_read_b128 v[128:131], v4 offset:28800
  buffer_load_dwordx4 v14, s[12:15], s33 offen lds
  v_mfma_f32_16x16x32_bf16 v[192:195], a[208:211], v[112:115], v[192:195]
  v_mfma_f32_16x16x32_bf16 v[196:199], v[224:227], v[112:115], v[196:199]
  s_waitcnt lgkmcnt(1)
  v_mfma_f32_16x16x32_bf16 v[196:199], v[228:231], v[116:119], v[196:199]
  v_mfma_f32_16x16x32_bf16 v[192:195], a[212:215], v[116:119], v[192:195]
  s_waitcnt vmcnt(6)
  v_mfma_f32_16x16x32_bf16 v[192:195], v[228:231], v[120:123], v[192:195]
  v_mfma_f32_16x16x32_bf16 v[188:191], a[152:155], v[116:119], v[188:191]
  s_barrier
  v_mfma_f32_16x16x32_bf16 v[188:191], a[212:215], v[120:123], v[188:191]
  ds_read_b64_tr_b16 a[36:37], v15 offset:10240
  s_mov_b32 s33, 73728
  v_mfma_f32_16x16x32_bf16 v[188:191], v[228:231], v[124:127], v[188:191]
  ds_read_b64_tr_b16 a[38:39], v15 offset:11264
  s_add_u32 m0, s34, 0
  v_mfma_f32_16x16x32_bf16 v[184:187], a[92:95], v[116:119], v[184:187]
  ds_read_b64_tr_b16 a[96:97], v15 offset:12288
  ds_read_b64_tr_b16 a[98:99], v15 offset:13312
  v_mfma_f32_16x16x32_bf16 v[184:187], a[152:155], v[120:123], v[184:187]
  ds_read_b64_tr_b16 a[156:157], v15 offset:14336
  buffer_load_dwordx4 v14, s[12:15], s33 offen lds
  v_mfma_f32_16x16x32_bf16 v[184:187], a[212:215], v[124:127], v[184:187]
  ds_read_b128 v[132:135], v5 offset:28672
  ds_read_b64_tr_b16 a[158:159], v15 offset:15360
  s_waitcnt lgkmcnt(7)
  v_mfma_f32_16x16x32_bf16 v[184:187], v[228:231], v[128:131], v[184:187]
  ds_read_b64_tr_b16 a[216:217], v15 offset:16384
  s_mov_b32 s33, 258048
  v_mfma_f32_16x16x32_bf16 v[180:183], a[32:35], v[116:119], v[180:183]
  ds_read_b128 v[136:139], v5 offset:35840
  ds_read_b64_tr_b16 a[218:219], v15 offset:17408
  v_mfma_f32_16x16x32_bf16 v[180:183], a[92:95], v[120:123], v[180:183]
  ds_read_b64_tr_b16 v[232:233], v15 offset:18432
  s_add_u32 m0, s34, 4096
  v_mfma_f32_16x16x32_bf16 v[180:183], a[152:155], v[124:127], v[180:183]
  ds_read_b64_tr_b16 v[234:235], v15 offset:19456
  buffer_load_dwordx4 v14, s[12:15], s33 offen lds
  v_mfma_f32_16x16x32_bf16 v[180:183], a[212:215], v[128:131], v[180:183]
  ds_read_b128 v[140:143], v5 offset:43008
  v_mfma_f32_16x16x32_bf16 v[176:179], a[32:35], v[120:123], v[176:179]
  s_mov_b32 s33, 442368
  v_mfma_f32_16x16x32_bf16 v[176:179], a[92:95], v[124:127], v[176:179]
  v_mfma_f32_16x16x32_bf16 v[176:179], a[152:155], v[128:131], v[176:179]
  s_mov_b32 m0, s37
  v_mfma_f32_16x16x32_bf16 v[172:175], a[32:35], v[124:127], v[172:175]
  ds_read_b128 v[144:147], v5 offset:50176
  v_mfma_f32_16x16x32_bf16 v[172:175], a[92:95], v[128:131], v[172:175]
  buffer_load_dwordx4 v14, s[12:15], s33 offen lds
  v_mfma_f32_16x16x32_bf16 v[168:171], a[32:35], v[128:131], v[168:171]
  s_waitcnt lgkmcnt(1)
  v_mfma_f32_16x16x32_bf16 v[168:171], a[36:39], v[132:135], v[168:171]
  v_mfma_f32_16x16x32_bf16 v[172:175], a[96:99], v[132:135], v[172:175]
  s_waitcnt vmcnt(6)
  v_mfma_f32_16x16x32_bf16 v[172:175], a[36:39], v[136:139], v[172:175]
  v_mfma_f32_16x16x32_bf16 v[176:179], a[156:159], v[132:135], v[176:179]
  s_barrier
  v_mfma_f32_16x16x32_bf16 v[176:179], a[96:99], v[136:139], v[176:179]
  ds_read_b64_tr_b16 v[236:237], v15 offset:28672
  s_mov_b32 s33, 79872
  v_mfma_f32_16x16x32_bf16 v[176:179], a[36:39], v[140:143], v[176:179]
  ds_read_b64_tr_b16 v[238:239], v15 offset:29696
  s_add_u32 m0, s34, 10240
  v_mfma_f32_16x16x32_bf16 v[180:183], a[216:219], v[132:135], v[180:183]
  ds_read_b64_tr_b16 a[220:221], v15 offset:26624
  ds_read_b64_tr_b16 a[222:223], v15 offset:27648
  v_mfma_f32_16x16x32_bf16 v[180:183], a[156:159], v[136:139], v[180:183]
  ds_read_b64_tr_b16 a[160:161], v15 offset:24576
  buffer_load_dwordx4 v14, s[12:15], s33 offen lds
  v_mfma_f32_16x16x32_bf16 v[180:183], a[96:99], v[140:143], v[180:183]
  ds_read_b128 v[148:151], v5 offset:50240
  s_mov_b32 s33, 264192
  s_waitcnt lgkmcnt(6)
  v_mfma_f32_16x16x32_bf16 v[180:183], a[36:39], v[144:147], v[180:183]
  ds_read_b64_tr_b16 a[162:163], v15 offset:25600
  ds_read_b64_tr_b16 a[100:101], v15 offset:22528
  v_mfma_f32_16x16x32_bf16 v[184:187], v[232:235], v[132:135], v[184:187]
  ds_read_b128 v[152:155], v5 offset:43072
  s_add_u32 m0, s34, 14336
  v_mfma_f32_16x16x32_bf16 v[184:187], a[216:219], v[136:139], v[184:187]
  ds_read_b64_tr_b16 a[102:103], v15 offset:23552
  buffer_load_dwordx4 v14, s[12:15], s33 offen lds
  v_mfma_f32_16x16x32_bf16 v[184:187], a[156:159], v[140:143], v[184:187]
  ds_read_b64_tr_b16 a[40:41], v15 offset:20480
  ds_read_b64_tr_b16 a[42:43], v15 offset:21504
  v_mfma_f32_16x16x32_bf16 v[184:187], a[96:99], v[144:147], v[184:187]
  ds_read_b128 v[156:159], v5 offset:35904
  s_mov_b32 s33, 448512
  v_mfma_f32_16x16x32_bf16 v[188:191], v[232:235], v[136:139], v[188:191]
  s_and_b32 s39, s38, 10240
  v_mfma_f32_16x16x32_bf16 v[188:191], a[216:219], v[140:143], v[188:191]
  v_mfma_f32_16x16x32_bf16 v[188:191], a[156:159], v[144:147], v[188:191]
  s_add_u32 m0, s37, s39
  v_mfma_f32_16x16x32_bf16 v[192:195], v[232:235], v[140:143], v[192:195]
  ds_read_b128 v[160:163], v5 offset:28736
  buffer_load_dwordx4 v14, s[12:15], s33 offen lds
  v_mfma_f32_16x16x32_bf16 v[192:195], a[216:219], v[144:147], v[192:195]
  v_mfma_f32_16x16x32_bf16 v[196:199], v[232:235], v[144:147], v[196:199]
  s_waitcnt lgkmcnt(1)
  v_mfma_f32_16x16x32_bf16 v[196:199], v[236:239], v[148:151], v[196:199]
  v_mfma_f32_16x16x32_bf16 v[192:195], a[220:223], v[148:151], v[192:195]
  s_waitcnt vmcnt(6)
  v_mfma_f32_16x16x32_bf16 v[192:195], v[236:239], v[152:155], v[192:195]
  v_mfma_f32_16x16x32_bf16 v[188:191], a[160:163], v[148:151], v[188:191]
  s_barrier
  v_mfma_f32_16x16x32_bf16 v[188:191], a[220:223], v[152:155], v[188:191]
  ds_read_b64_tr_b16 a[44:45], v15 offset:30720
  s_mov_b32 s33, 86016
  v_mfma_f32_16x16x32_bf16 v[188:191], v[236:239], v[156:159], v[188:191]
  ds_read_b64_tr_b16 a[46:47], v15 offset:31744
  s_add_u32 m0, s34, 20480
  v_mfma_f32_16x16x32_bf16 v[184:187], a[100:103], v[148:151], v[184:187]
  ds_read_b64_tr_b16 a[104:105], v15 offset:32768
  buffer_load_dwordx4 v14, s[12:15], s33 offen lds
  v_mfma_f32_16x16x32_bf16 v[184:187], a[160:163], v[152:155], v[184:187]
  ds_read_b64_tr_b16 a[106:107], v15 offset:33792
  s_mov_b32 s33, 270336
  v_mfma_f32_16x16x32_bf16 v[184:187], a[220:223], v[156:159], v[184:187]
  ds_read_b128 v[164:167], v5 offset:28800
  s_add_u32 m0, s34, 24576
  s_waitcnt lgkmcnt(5)
  v_mfma_f32_16x16x32_bf16 v[184:187], v[236:239], v[160:163], v[184:187]
  ds_read_b64_tr_b16 a[164:165], v15 offset:34816
  buffer_load_dwordx4 v14, s[12:15], s33 offen lds
  v_mfma_f32_16x16x32_bf16 v[180:183], a[40:43], v[148:151], v[180:183]
  ds_read_b128 v[108:111], v5 offset:35968
  s_mov_b32 s33, 454656
  v_mfma_f32_16x16x32_bf16 v[180:183], a[100:103], v[152:155], v[180:183]
  ds_read_b64_tr_b16 a[166:167], v15 offset:35840
  s_and_b32 s39, s38, 20480
  v_mfma_f32_16x16x32_bf16 v[180:183], a[160:163], v[156:159], v[180:183]
  ds_read_b64_tr_b16 a[224:225], v15 offset:36864
  s_add_u32 m0, s37, s39
  v_mfma_f32_16x16x32_bf16 v[180:183], a[220:223], v[160:163], v[180:183]
  ds_read_b128 v[112:115], v5 offset:43136
  buffer_load_dwordx4 v14, s[12:15], s33 offen lds
  v_mfma_f32_16x16x32_bf16 v[176:179], a[40:43], v[152:155], v[176:179]
  ds_read_b64_tr_b16 a[226:227], v15 offset:37888
  s_add_u32 s30, s26, 129024
  v_mfma_f32_16x16x32_bf16 v[176:179], a[100:103], v[156:159], v[176:179]
  ds_read_b64_tr_b16 v[240:241], v15 offset:38912
  s_sub_u32 s31, s30, 9633792
  v_mfma_f32_16x16x32_bf16 v[176:179], a[160:163], v[160:163], v[176:179]
  ds_read_b64_tr_b16 v[242:243], v15 offset:39936
  s_min_u32 s27, s30, s31
  v_mfma_f32_16x16x32_bf16 v[172:175], a[40:43], v[156:159], v[172:175]
  ds_read_b128 v[116:119], v5 offset:50304
  s_add_u32 m0, s23, 21504
  v_mfma_f32_16x16x32_bf16 v[172:175], a[100:103], v[160:163], v[172:175]
  buffer_load_dwordx4 v12, s[8:11], s27 offen lds
  s_and_b32 s32, s25, 21504
  v_mfma_f32_16x16x32_bf16 v[168:171], a[40:43], v[160:163], v[168:171]
  s_add_u32 m0, s24, s32
  s_nop 0
  buffer_load_dwordx4 v13, s[8:11], s27 offen lds
  s_waitcnt lgkmcnt(3)
  v_mfma_f32_16x16x32_bf16 v[168:171], a[44:47], v[164:167], v[168:171]
  s_add_u32 s30, s26, 86016
  s_sub_u32 s31, s30, 9633792
  v_mfma_f32_16x16x32_bf16 v[172:175], a[104:107], v[164:167], v[172:175]
  s_min_u32 s27, s30, s31
  s_add_u32 m0, s23, 14336
  s_waitcnt vmcnt(8)
  v_mfma_f32_16x16x32_bf16 v[172:175], a[44:47], v[108:111], v[172:175]
  buffer_load_dwordx4 v12, s[8:11], s27 offen lds
  s_and_b32 s32, s25, 14336
  s_waitcnt lgkmcnt(1)
  v_mfma_f32_16x16x32_bf16 v[176:179], a[164:167], v[164:167], v[176:179]
  s_add_u32 m0, s24, s32
  s_nop 0
  buffer_load_dwordx4 v13, s[8:11], s27 offen lds
  s_barrier
  v_mfma_f32_16x16x32_bf16 v[176:179], a[104:107], v[108:111], v[176:179]
  ds_read_b64_tr_b16 v[244:245], v15 offset:8192
  s_add_u32 s30, s26, 43008
  v_mfma_f32_16x16x32_bf16 v[176:179], a[44:47], v[112:115], v[176:179]
  ds_read_b64_tr_b16 v[246:247], v15 offset:9216
  s_sub_u32 s31, s30, 9633792
  v_mfma_f32_16x16x32_bf16 v[180:183], a[224:227], v[164:167], v[180:183]
  ds_read_b64_tr_b16 a[228:229], v15 offset:6144
  s_min_u32 s27, s30, s31
  v_mfma_f32_16x16x32_bf16 v[180:183], a[164:167], v[108:111], v[180:183]
  ds_read_b64_tr_b16 a[230:231], v15 offset:7168
  s_add_u32 m0, s23, 7168
  v_mfma_f32_16x16x32_bf16 v[180:183], a[104:107], v[112:115], v[180:183]
  ds_read_b128 v[120:123], v6 offset:50176
  buffer_load_dwordx4 v12, s[8:11], s27 offen lds
  s_waitcnt lgkmcnt(5)
  v_mfma_f32_16x16x32_bf16 v[180:183], a[44:47], v[116:119], v[180:183]
  ds_read_b64_tr_b16 a[168:169], v15 offset:4096
  s_and_b32 s32, s25, 7168
  v_mfma_f32_16x16x32_bf16 v[184:187], v[240:243], v[164:167], v[184:187]
  ds_read_b128 v[124:127], v6 offset:43008
  s_add_u32 m0, s24, s32
  v_mfma_f32_16x16x32_bf16 v[184:187], a[224:227], v[108:111], v[184:187]
  ds_read_b64_tr_b16 a[170:171], v15 offset:5120
  buffer_load_dwordx4 v13, s[8:11], s27 offen lds
  v_mfma_f32_16x16x32_bf16 v[184:187], a[164:167], v[112:115], v[184:187]
  ds_read_b64_tr_b16 a[108:109], v15 offset:2048
  s_add_u32 s30, s26, 0
  v_mfma_f32_16x16x32_bf16 v[184:187], a[104:107], v[116:119], v[184:187]
  ds_read_b128 v[128:131], v6 offset:35840
  s_sub_u32 s31, s30, 9633792
  v_mfma_f32_16x16x32_bf16 v[188:191], v[240:243], v[108:111], v[188:191]
  ds_read_b64_tr_b16 a[110:111], v15 offset:3072
  s_min_u32 s27, s30, s31
  v_mfma_f32_16x16x32_bf16 v[188:191], a[224:227], v[112:115], v[188:191]
  ds_read_b64_tr_b16 a[48:49], v15 offset:0
  s_add_u32 m0, s23, 0
  v_mfma_f32_16x16x32_bf16 v[188:191], a[164:167], v[116:119], v[188:191]
  ds_read_b64_tr_b16 a[50:51], v15 offset:1024
  buffer_load_dwordx4 v12, s[8:11], s27 offen lds
  v_mfma_f32_16x16x32_bf16 v[192:195], v[240:243], v[112:115], v[192:195]
  ds_read_b128 v[132:135], v6 offset:28672
  s_mov_b32 m0, s24
  v_mfma_f32_16x16x32_bf16 v[192:195], a[224:227], v[116:119], v[192:195]
  buffer_load_dwordx4 v13, s[8:11], s27 offen lds
  v_mfma_f32_16x16x32_bf16 v[196:199], v[240:243], v[116:119], v[196:199]
  s_waitcnt lgkmcnt(3)
  v_mfma_f32_16x16x32_bf16 v[196:199], v[244:247], v[120:123], v[196:199]
  v_mfma_f32_16x16x32_bf16 v[192:195], a[228:231], v[120:123], v[192:195]
  s_waitcnt vmcnt(11)
  v_mfma_f32_16x16x32_bf16 v[192:195], v[244:247], v[124:127], v[192:195]
  s_waitcnt lgkmcnt(1)
  v_mfma_f32_16x16x32_bf16 v[188:191], a[168:171], v[120:123], v[188:191]
  s_barrier
  v_mfma_f32_16x16x32_bf16 v[188:191], a[228:231], v[124:127], v[188:191]
  ds_read_b64_tr_b16 a[52:53], v15 offset:10240
  s_add_u32 s30, s26, 344064
  v_mfma_f32_16x16x32_bf16 v[188:191], v[244:247], v[128:131], v[188:191]
  ds_read_b64_tr_b16 a[54:55], v15 offset:11264
  ds_read_b64_tr_b16 a[112:113], v15 offset:12288
  v_mfma_f32_16x16x32_bf16 v[184:187], a[108:111], v[120:123], v[184:187]
  ds_read_b64_tr_b16 a[114:115], v15 offset:13312
  s_sub_u32 s31, s30, 9633792
  v_mfma_f32_16x16x32_bf16 v[184:187], a[168:171], v[124:127], v[184:187]
  ds_read_b64_tr_b16 a[172:173], v15 offset:14336
  ds_read_b64_tr_b16 a[174:175], v15 offset:15360
  v_mfma_f32_16x16x32_bf16 v[184:187], a[228:231], v[128:131], v[184:187]
  ds_read_b128 v[136:139], v6 offset:28736
  s_min_u32 s27, s30, s31
  s_waitcnt lgkmcnt(7)
  v_mfma_f32_16x16x32_bf16 v[184:187], v[244:247], v[132:135], v[184:187]
  ds_read_b64_tr_b16 a[232:233], v15 offset:16384
  ds_read_b64_tr_b16 a[234:235], v15 offset:17408
  v_mfma_f32_16x16x32_bf16 v[180:183], a[48:51], v[120:123], v[180:183]
  ds_read_b128 v[140:143], v6 offset:35904
  s_add_u32 m0, s23, 57344
  v_mfma_f32_16x16x32_bf16 v[180:183], a[108:111], v[124:127], v[180:183]
  ds_read_b64_tr_b16 v[248:249], v15 offset:18432
  ds_read_b64_tr_b16 v[250:251], v15 offset:19456
  v_mfma_f32_16x16x32_bf16 v[180:183], a[168:171], v[128:131], v[180:183]
  buffer_load_dwordx4 v12, s[8:11], s27 offen lds
  v_mfma_f32_16x16x32_bf16 v[180:183], a[228:231], v[132:135], v[180:183]
  ds_read_b128 v[144:147], v6 offset:43072
  v_mfma_f32_16x16x32_bf16 v[176:179], a[48:51], v[124:127], v[176:179]
  s_and_b32 s32, s25, 57344
  v_mfma_f32_16x16x32_bf16 v[176:179], a[108:111], v[128:131], v[176:179]
  v_mfma_f32_16x16x32_bf16 v[176:179], a[168:171], v[132:135], v[176:179]
  s_add_u32 m0, s24, s32
  v_mfma_f32_16x16x32_bf16 v[172:175], a[48:51], v[128:131], v[172:175]
  ds_read_b128 v[148:151], v6 offset:50240
  v_mfma_f32_16x16x32_bf16 v[172:175], a[108:111], v[132:135], v[172:175]
  buffer_load_dwordx4 v13, s[8:11], s27 offen lds
  v_mfma_f32_16x16x32_bf16 v[168:171], a[48:51], v[132:135], v[168:171]
  s_waitcnt lgkmcnt(1)
  v_mfma_f32_16x16x32_bf16 v[168:171], a[52:55], v[136:139], v[168:171]
  v_mfma_f32_16x16x32_bf16 v[172:175], a[112:115], v[136:139], v[172:175]
  s_waitcnt vmcnt(10)
  v_mfma_f32_16x16x32_bf16 v[172:175], a[52:55], v[140:143], v[172:175]
  v_mfma_f32_16x16x32_bf16 v[176:179], a[172:175], v[136:139], v[176:179]
  s_barrier
  v_mfma_f32_16x16x32_bf16 v[176:179], a[112:115], v[140:143], v[176:179]
  ds_read_b64_tr_b16 v[252:253], v15 offset:28672
  s_add_u32 s30, s26, 387072
  v_mfma_f32_16x16x32_bf16 v[176:179], a[52:55], v[144:147], v[176:179]
  ds_read_b64_tr_b16 v[254:255], v15 offset:29696
  ds_read_b64_tr_b16 a[236:237], v15 offset:26624
  v_mfma_f32_16x16x32_bf16 v[180:183], a[232:235], v[136:139], v[180:183]
  ds_read_b64_tr_b16 a[238:239], v15 offset:27648
  ds_read_b64_tr_b16 a[176:177], v15 offset:24576
  v_mfma_f32_16x16x32_bf16 v[180:183], a[172:175], v[140:143], v[180:183]
  ds_read_b64_tr_b16 a[178:179], v15 offset:25600
  s_sub_u32 s31, s30, 9633792
  v_mfma_f32_16x16x32_bf16 v[180:183], a[112:115], v[144:147], v[180:183]
  ds_read_b128 v[152:155], v6 offset:50304
  ds_read_b64_tr_b16 a[116:117], v15 offset:22528
  s_waitcnt lgkmcnt(8)
  v_mfma_f32_16x16x32_bf16 v[180:183], a[52:55], v[148:151], v[180:183]
  ds_read_b64_tr_b16 a[118:119], v15 offset:23552
  ds_read_b64_tr_b16 a[56:57], v15 offset:20480
  v_mfma_f32_16x16x32_bf16 v[184:187], v[248:251], v[136:139], v[184:187]
  ds_read_b128 v[156:159], v6 offset:43136
  ds_read_b64_tr_b16 a[58:59], v15 offset:21504
  v_mfma_f32_16x16x32_bf16 v[184:187], a[232:235], v[140:143], v[184:187]
  s_min_u32 s27, s30, s31
  v_mfma_f32_16x16x32_bf16 v[184:187], a[172:175], v[144:147], v[184:187]
  v_mfma_f32_16x16x32_bf16 v[184:187], a[112:115], v[148:151], v[184:187]
  ds_read_b128 v[160:163], v6 offset:35968
  v_mfma_f32_16x16x32_bf16 v[188:191], v[248:251], v[140:143], v[188:191]
  v_mfma_f32_16x16x32_bf16 v[188:191], a[232:235], v[144:147], v[188:191]
  s_add_u32 m0, s23, 64512
  v_mfma_f32_16x16x32_bf16 v[188:191], a[172:175], v[148:151], v[188:191]
  v_mfma_f32_16x16x32_bf16 v[192:195], v[248:251], v[144:147], v[192:195]
  ds_read_b128 v[164:167], v6 offset:28800
  v_mfma_f32_16x16x32_bf16 v[192:195], a[232:235], v[148:151], v[192:195]
  v_mfma_f32_16x16x32_bf16 v[196:199], v[248:251], v[148:151], v[196:199]
  buffer_load_dwordx4 v12, s[8:11], s27 offen lds
  s_waitcnt lgkmcnt(1)
  v_mfma_f32_16x16x32_bf16 v[196:199], v[252:255], v[152:155], v[196:199]
  v_mfma_f32_16x16x32_bf16 v[192:195], a[236:239], v[152:155], v[192:195]
  v_mfma_f32_16x16x32_bf16 v[192:195], v[252:255], v[156:159], v[192:195]
  s_and_b32 s32, s25, 64512
  v_mfma_f32_16x16x32_bf16 v[188:191], a[176:179], v[152:155], v[188:191]
  v_mfma_f32_16x16x32_bf16 v[188:191], a[236:239], v[156:159], v[188:191]
  v_mfma_f32_16x16x32_bf16 v[188:191], v[252:255], v[160:163], v[188:191]
  s_waitcnt vmcnt(7)
  s_barrier
  v_mfma_f32_16x16x32_bf16 v[184:187], a[116:119], v[152:155], v[184:187]
  ds_read_b128 v[48:51], v2 offset:21504
  s_add_u32 m0, s24, s32
  v_mfma_f32_16x16x32_bf16 v[184:187], a[176:179], v[156:159], v[184:187]
  ds_read_b128 v[52:55], v2 offset:21568
  ds_read_b128 v[56:59], v2 offset:21632
  v_mfma_f32_16x16x32_bf16 v[184:187], a[236:239], v[160:163], v[184:187]
  ds_read_b128 v[60:63], v3 offset:21504
  ds_read_b128 v[64:67], v3 offset:21568
  s_waitcnt lgkmcnt(5)
  v_mfma_f32_16x16x32_bf16 v[184:187], v[252:255], v[164:167], v[184:187]
  ds_read_b128 v[68:71], v3 offset:21632
  ds_read_b128 v[72:75], v4 offset:21504
  v_mfma_f32_16x16x32_bf16 v[180:183], a[56:59], v[152:155], v[180:183]
  ds_read_b128 v[76:79], v4 offset:21568
  buffer_load_dwordx4 v13, s[8:11], s27 offen lds
  v_mfma_f32_16x16x32_bf16 v[180:183], a[116:119], v[156:159], v[180:183]
  ds_read_b128 v[80:83], v4 offset:21632
  ds_read_b128 v[84:87], v5 offset:21504
  v_mfma_f32_16x16x32_bf16 v[180:183], a[176:179], v[160:163], v[180:183]
  ds_read_b128 v[88:91], v5 offset:21568
  ds_read_b128 v[92:95], v5 offset:21632
  v_mfma_f32_16x16x32_bf16 v[180:183], a[236:239], v[164:167], v[180:183]
  ds_read_b128 v[96:99], v6 offset:21504
  ds_read_b128 v[100:103], v6 offset:21568
  v_mfma_f32_16x16x32_bf16 v[176:179], a[56:59], v[156:159], v[176:179]
  v_mfma_f32_16x16x32_bf16 v[176:179], a[116:119], v[160:163], v[176:179]
  v_mfma_f32_16x16x32_bf16 v[176:179], a[176:179], v[164:167], v[176:179]
  v_mfma_f32_16x16x32_bf16 v[172:175], a[56:59], v[160:163], v[172:175]
  v_mfma_f32_16x16x32_bf16 v[172:175], a[116:119], v[164:167], v[172:175]
  v_mfma_f32_16x16x32_bf16 v[168:171], a[56:59], v[164:167], v[168:171]
  ds_read_b128 v[104:107], v6 offset:21632
  s_waitcnt lgkmcnt(1)
  v_mfma_f32_16x16x32_bf16 v[168:171], a[60:63], v[48:51], v[168:171]
  ds_read_b128 v[108:111], v2 offset:14336
  v_mfma_f32_16x16x32_bf16 v[168:171], a[64:67], v[52:55], v[168:171]
  v_mfma_f32_16x16x32_bf16 v[168:171], a[68:71], v[56:59], v[168:171]
  s_add_u32 s30, s26, 430080
  v_mfma_f32_16x16x32_bf16 v[168:171], a[72:75], v[60:63], v[168:171]
  ds_read_b128 v[112:115], v2 offset:14400
  s_sub_u32 s31, s30, 9633792
  v_mfma_f32_16x16x32_bf16 v[168:171], a[76:79], v[64:67], v[168:171]
  s_min_u32 s27, s30, s31
  v_mfma_f32_16x16x32_bf16 v[168:171], a[80:83], v[68:71], v[168:171]
  s_add_u32 m0, s23, 71680
  v_mfma_f32_16x16x32_bf16 v[168:171], a[84:87], v[72:75], v[168:171]
  buffer_load_dwordx4 v12, s[8:11], s27 offen lds
  v_mfma_f32_16x16x32_bf16 v[168:171], a[88:91], v[76:79], v[168:171]
  ds_read_b128 v[116:119], v2 offset:14464
  s_and_b32 s32, s25, 71680
  v_mfma_f32_16x16x32_bf16 v[168:171], a[92:95], v[80:83], v[168:171]
  s_add_u32 m0, s24, s32
  v_mfma_f32_16x16x32_bf16 v[168:171], a[96:99], v[84:87], v[168:171]
  buffer_load_dwordx4 v13, s[8:11], s27 offen lds
  v_mfma_f32_16x16x32_bf16 v[168:171], a[100:103], v[88:91], v[168:171]
  ds_read_b128 v[120:123], v3 offset:14336
  s_add_u32 s30, s26, 473088
  v_mfma_f32_16x16x32_bf16 v[168:171], a[104:107], v[92:95], v[168:171]
  s_sub_u32 s31, s30, 9633792
  v_mfma_f32_16x16x32_bf16 v[168:171], a[108:111], v[96:99], v[168:171]
  s_min_u32 s27, s30, s31
  v_mfma_f32_16x16x32_bf16 v[168:171], a[112:115], v[100:103], v[168:171]
  s_add_u32 m0, s23, 78848
  s_waitcnt lgkmcnt(1)
  v_mfma_f32_16x16x32_bf16 v[168:171], a[116:119], v[104:107], v[168:171]
  ds_read_b128 v[124:127], v3 offset:14400
  buffer_load_dwordx4 v12, s[8:11], s27 offen lds
  v_mfma_f32_16x16x32_bf16 v[172:175], a[120:123], v[48:51], v[172:175]
  s_and_b32 s32, s25, 78848
  v_mfma_f32_16x16x32_bf16 v[172:175], a[124:127], v[52:55], v[172:175]
  s_add_u32 m0, s24, s32
  v_mfma_f32_16x16x32_bf16 v[172:175], a[128:131], v[56:59], v[172:175]
  buffer_load_dwordx4 v13, s[8:11], s27 offen lds
  v_mfma_f32_16x16x32_bf16 v[172:175], a[132:135], v[60:63], v[172:175]
  ds_read_b128 v[128:131], v3 offset:14464
  v_mfma_f32_16x16x32_bf16 v[172:175], a[136:139], v[64:67], v[172:175]
  v_mfma_f32_16x16x32_bf16 v[172:175], a[140:143], v[68:71], v[172:175]
  v_mfma_f32_16x16x32_bf16 v[172:175], a[144:147], v[72:75], v[172:175]
  ds_read_b128 v[132:135], v4 offset:14336
  v_mfma_f32_16x16x32_bf16 v[172:175], a[148:151], v[76:79], v[172:175]
  v_mfma_f32_16x16x32_bf16 v[172:175], a[152:155], v[80:83], v[172:175]
  v_mfma_f32_16x16x32_bf16 v[172:175], a[156:159], v[84:87], v[172:175]
  v_mfma_f32_16x16x32_bf16 v[172:175], a[160:163], v[88:91], v[172:175]
  ds_read_b128 v[136:139], v4 offset:14400
  v_mfma_f32_16x16x32_bf16 v[172:175], a[164:167], v[92:95], v[172:175]
  v_mfma_f32_16x16x32_bf16 v[172:175], a[168:171], v[96:99], v[172:175]
  v_mfma_f32_16x16x32_bf16 v[172:175], a[172:175], v[100:103], v[172:175]
  ds_read_b128 v[140:143], v4 offset:14464
  v_mfma_f32_16x16x32_bf16 v[172:175], a[176:179], v[104:107], v[172:175]
  v_mfma_f32_16x16x32_bf16 v[176:179], a[180:183], v[48:51], v[176:179]
  v_mfma_f32_16x16x32_bf16 v[176:179], a[184:187], v[52:55], v[176:179]
  v_mfma_f32_16x16x32_bf16 v[176:179], a[188:191], v[56:59], v[176:179]
  ds_read_b128 v[144:147], v5 offset:14336
  v_mfma_f32_16x16x32_bf16 v[176:179], a[192:195], v[60:63], v[176:179]
  v_mfma_f32_16x16x32_bf16 v[176:179], a[196:199], v[64:67], v[176:179]
  v_mfma_f32_16x16x32_bf16 v[176:179], a[200:203], v[68:71], v[176:179]
  v_mfma_f32_16x16x32_bf16 v[176:179], a[204:207], v[72:75], v[176:179]
  ds_read_b128 v[148:151], v5 offset:14400
  v_mfma_f32_16x16x32_bf16 v[176:179], a[208:211], v[76:79], v[176:179]
  v_mfma_f32_16x16x32_bf16 v[176:179], a[212:215], v[80:83], v[176:179]
  v_mfma_f32_16x16x32_bf16 v[176:179], a[216:219], v[84:87], v[176:179]
  ds_read_b128 v[152:155], v5 offset:14464
  v_mfma_f32_16x16x32_bf16 v[176:179], a[220:223], v[88:91], v[176:179]
  v_mfma_f32_16x16x32_bf16 v[176:179], a[224:227], v[92:95], v[176:179]
  v_mfma_f32_16x16x32_bf16 v[176:179], a[228:231], v[96:99], v[176:179]
  v_mfma_f32_16x16x32_bf16 v[176:179], a[232:235], v[100:103], v[176:179]
  ds_read_b128 v[156:159], v6 offset:14336
  v_mfma_f32_16x16x32_bf16 v[176:179], a[236:239], v[104:107], v[176:179]
  v_mfma_f32_16x16x32_bf16 v[180:183], a[240:243], v[48:51], v[180:183]
  v_mfma_f32_16x16x32_bf16 v[180:183], a[244:247], v[52:55], v[180:183]
  ds_read_b128 v[160:163], v6 offset:14400
  v_mfma_f32_16x16x32_bf16 v[180:183], a[248:251], v[56:59], v[180:183]
  v_mfma_f32_16x16x32_bf16 v[180:183], a[252:255], v[60:63], v[180:183]
  v_mfma_f32_16x16x32_bf16 v[180:183], v[212:215], v[64:67], v[180:183]
  v_mfma_f32_16x16x32_bf16 v[180:183], v[216:219], v[68:71], v[180:183]
  ds_read_b128 v[164:167], v6 offset:14464
  v_mfma_f32_16x16x32_bf16 v[180:183], v[220:223], v[72:75], v[180:183]
  v_mfma_f32_16x16x32_bf16 v[180:183], v[224:227], v[76:79], v[180:183]
  v_mfma_f32_16x16x32_bf16 v[180:183], v[228:231], v[80:83], v[180:183]
  v_mfma_f32_16x16x32_bf16 v[180:183], v[232:235], v[84:87], v[180:183]
  v_mfma_f32_16x16x32_bf16 v[180:183], v[236:239], v[88:91], v[180:183]
  v_mfma_f32_16x16x32_bf16 v[180:183], v[240:243], v[92:95], v[180:183]
  v_mfma_f32_16x16x32_bf16 v[180:183], v[244:247], v[96:99], v[180:183]
  v_mfma_f32_16x16x32_bf16 v[180:183], v[248:251], v[100:103], v[180:183]
  v_mfma_f32_16x16x32_bf16 v[180:183], v[252:255], v[104:107], v[180:183]
  s_waitcnt vmcnt(8)
  s_barrier
  v_mfma_f32_16x16x32_bf16 v[168:171], a[120:123], v[108:111], v[168:171]
  ds_read_b128 v[48:51], v2 offset:7168
  v_mfma_f32_16x16x32_bf16 v[168:171], a[124:127], v[112:115], v[168:171]
  v_mfma_f32_16x16x32_bf16 v[168:171], a[128:131], v[116:119], v[168:171]
  ds_read_b128 v[52:55], v2 offset:7232
  s_add_u32 s30, s26, 516096
  s_waitcnt lgkmcnt(2)
  v_mfma_f32_16x16x32_bf16 v[168:171], a[132:135], v[120:123], v[168:171]
  s_sub_u32 s31, s30, 9633792
  v_mfma_f32_16x16x32_bf16 v[168:171], a[136:139], v[124:127], v[168:171]
  s_min_u32 s27, s30, s31
  v_mfma_f32_16x16x32_bf16 v[168:171], a[140:143], v[128:131], v[168:171]
  ds_read_b128 v[56:59], v2 offset:7296
  s_add_u32 m0, s23, 86016
  v_mfma_f32_16x16x32_bf16 v[168:171], a[144:147], v[132:135], v[168:171]
  buffer_load_dwordx4 v12, s[8:11], s27 offen lds
  v_mfma_f32_16x16x32_bf16 v[168:171], a[148:151], v[136:139], v[168:171]
  ds_read_b128 v[60:63], v3 offset:7168
  s_and_b32 s32, s25, 86016
  v_mfma_f32_16x16x32_bf16 v[168:171], a[152:155], v[140:143], v[168:171]
  s_add_u32 m0, s24, s32
  v_mfma_f32_16x16x32_bf16 v[168:171], a[156:159], v[144:147], v[168:171]
  s_add_u32 s51, s50, 129024
  buffer_load_dwordx4 v13, s[8:11], s27 offen lds
  v_mfma_f32_16x16x32_bf16 v[168:171], a[160:163], v[148:151], v[168:171]
  ds_read_b128 v[64:67], v3 offset:7232
  v_cvt_pk_bf16_f32 v26, v180, v181
  v_mfma_f32_16x16x32_bf16 v[168:171], a[164:167], v[152:155], v[168:171]
  v_cvt_pk_bf16_f32 v27, v182, v183
  v_mfma_f32_16x16x32_bf16 v[168:171], a[168:171], v[156:159], v[168:171]
  buffer_store_dwordx2 v[26:27], v16, s[16:19], s51 offen nt
  v_mfma_f32_16x16x32_bf16 v[168:171], a[172:175], v[160:163], v[168:171]
  ds_read_b128 v[68:71], v3 offset:7296
  v_mfma_f32_16x16x32_bf16 v[168:171], a[176:179], v[164:167], v[168:171]
  v_mfma_f32_16x16x32_bf16 v[172:175], a[180:183], v[108:111], v[172:175]
  ds_read_b128 v[72:75], v4 offset:7168
  v_mfma_f32_16x16x32_bf16 v[172:175], a[184:187], v[112:115], v[172:175]
  v_mfma_f32_16x16x32_bf16 v[172:175], a[188:191], v[116:119], v[172:175]
  v_mfma_f32_16x16x32_bf16 v[172:175], a[192:195], v[120:123], v[172:175]
  ds_read_b128 v[76:79], v4 offset:7232
  v_mfma_f32_16x16x32_bf16 v[172:175], a[196:199], v[124:127], v[172:175]
  v_mfma_f32_16x16x32_bf16 v[172:175], a[200:203], v[128:131], v[172:175]
  ds_read_b128 v[80:83], v4 offset:7296
  v_mfma_f32_16x16x32_bf16 v[172:175], a[204:207], v[132:135], v[172:175]
  v_mfma_f32_16x16x32_bf16 v[172:175], a[208:211], v[136:139], v[172:175]
  v_mfma_f32_16x16x32_bf16 v[172:175], a[212:215], v[140:143], v[172:175]
  ds_read_b128 v[84:87], v5 offset:7168
  v_mfma_f32_16x16x32_bf16 v[172:175], a[216:219], v[144:147], v[172:175]
  v_mfma_f32_16x16x32_bf16 v[172:175], a[220:223], v[148:151], v[172:175]
  v_mfma_f32_16x16x32_bf16 v[172:175], a[224:227], v[152:155], v[172:175]
  ds_read_b128 v[88:91], v5 offset:7232
  v_mfma_f32_16x16x32_bf16 v[172:175], a[228:231], v[156:159], v[172:175]
  v_mfma_f32_16x16x32_bf16 v[172:175], a[232:235], v[160:163], v[172:175]
  ds_read_b128 v[92:95], v5 offset:7296
  v_mfma_f32_16x16x32_bf16 v[172:175], a[236:239], v[164:167], v[172:175]
  v_mfma_f32_16x16x32_bf16 v[176:179], a[240:243], v[108:111], v[176:179]
  v_mfma_f32_16x16x32_bf16 v[176:179], a[244:247], v[112:115], v[176:179]
  ds_read_b128 v[96:99], v6 offset:7168
  v_mfma_f32_16x16x32_bf16 v[176:179], a[248:251], v[116:119], v[176:179]
  v_mfma_f32_16x16x32_bf16 v[176:179], a[252:255], v[120:123], v[176:179]
  ds_read_b128 v[100:103], v6 offset:7232
  v_mfma_f32_16x16x32_bf16 v[176:179], v[212:215], v[124:127], v[176:179]
  v_mfma_f32_16x16x32_bf16 v[176:179], v[216:219], v[128:131], v[176:179]
  v_mfma_f32_16x16x32_bf16 v[176:179], v[220:223], v[132:135], v[176:179]
  ds_read_b128 v[104:107], v6 offset:7296
  v_mfma_f32_16x16x32_bf16 v[176:179], v[224:227], v[136:139], v[176:179]
  v_mfma_f32_16x16x32_bf16 v[176:179], v[228:231], v[140:143], v[176:179]
  v_mfma_f32_16x16x32_bf16 v[176:179], v[232:235], v[144:147], v[176:179]
  v_mfma_f32_16x16x32_bf16 v[176:179], v[236:239], v[148:151], v[176:179]
  v_mfma_f32_16x16x32_bf16 v[176:179], v[240:243], v[152:155], v[176:179]
  v_mfma_f32_16x16x32_bf16 v[176:179], v[244:247], v[156:159], v[176:179]
  v_mfma_f32_16x16x32_bf16 v[176:179], v[248:251], v[160:163], v[176:179]
  v_mfma_f32_16x16x32_bf16 v[176:179], v[252:255], v[164:167], v[176:179]
  s_waitcnt lgkmcnt(0)
  v_mfma_f32_16x16x32_bf16 v[168:171], a[180:183], v[48:51], v[168:171]
  ds_read_b128 v[108:111], v2 offset:0
  v_mfma_f32_16x16x32_bf16 v[168:171], a[184:187], v[52:55], v[168:171]
  ds_read_b128 v[112:115], v2 offset:64
  v_mfma_f32_16x16x32_bf16 v[168:171], a[188:191], v[56:59], v[168:171]
  v_mfma_f32_16x16x32_bf16 v[168:171], a[192:195], v[60:63], v[168:171]
  ds_read_b128 v[116:119], v2 offset:128
  v_mfma_f32_16x16x32_bf16 v[168:171], a[196:199], v[64:67], v[168:171]
  ds_read_b128 v[120:123], v3 offset:0
  v_mfma_f32_16x16x32_bf16 v[168:171], a[200:203], v[68:71], v[168:171]
  v_mfma_f32_16x16x32_bf16 v[168:171], a[204:207], v[72:75], v[168:171]
  ds_read_b128 v[124:127], v3 offset:64
  v_mfma_f32_16x16x32_bf16 v[168:171], a[208:211], v[76:79], v[168:171]
  v_mfma_f32_16x16x32_bf16 v[168:171], a[212:215], v[80:83], v[168:171]
  ds_read_b128 v[128:131], v3 offset:128
  v_mfma_f32_16x16x32_bf16 v[168:171], a[216:219], v[84:87], v[168:171]
  ds_read_b128 v[132:135], v4 offset:0
  s_add_u32 s51, s50, 86016
  v_mfma_f32_16x16x32_bf16 v[168:171], a[220:223], v[88:91], v[168:171]
  v_cvt_pk_bf16_f32 v26, v176, v177
  v_mfma_f32_16x16x32_bf16 v[168:171], a[224:227], v[92:95], v[168:171]
  ds_read_b128 v[136:139], v4 offset:64
  v_cvt_pk_bf16_f32 v27, v178, v179
  v_mfma_f32_16x16x32_bf16 v[168:171], a[228:231], v[96:99], v[168:171]
  ds_read_b128 v[140:143], v4 offset:128
  buffer_store_dwordx2 v[26:27], v16, s[16:19], s51 offen nt
  v_mfma_f32_16x16x32_bf16 v[168:171], a[232:235], v[100:103], v[168:171]
  v_mfma_f32_16x16x32_bf16 v[168:171], a[236:239], v[104:107], v[168:171]
  ds_read_b128 v[144:147], v5 offset:0
  v_mfma_f32_16x16x32_bf16 v[172:175], a[240:243], v[48:51], v[172:175]
  v_mfma_f32_16x16x32_bf16 v[172:175], a[244:247], v[52:55], v[172:175]
  ds_read_b128 v[148:151], v5 offset:64
  v_mfma_f32_16x16x32_bf16 v[172:175], a[248:251], v[56:59], v[172:175]
  ds_read_b128 v[152:155], v5 offset:128
  v_mfma_f32_16x16x32_bf16 v[172:175], a[252:255], v[60:63], v[172:175]
  v_mfma_f32_16x16x32_bf16 v[172:175], v[212:215], v[64:67], v[172:175]
  ds_read_b128 v[156:159], v6 offset:0
  v_mfma_f32_16x16x32_bf16 v[172:175], v[216:219], v[68:71], v[172:175]
  ds_read_b128 v[160:163], v6 offset:64
  v_mfma_f32_16x16x32_bf16 v[172:175], v[220:223], v[72:75], v[172:175]
  v_mfma_f32_16x16x32_bf16 v[172:175], v[224:227], v[76:79], v[172:175]
  ds_read_b128 v[164:167], v6 offset:128
  v_mfma_f32_16x16x32_bf16 v[172:175], v[228:231], v[80:83], v[172:175]
  v_mfma_f32_16x16x32_bf16 v[172:175], v[232:235], v[84:87], v[172:175]
  v_mfma_f32_16x16x32_bf16 v[172:175], v[236:239], v[88:91], v[172:175]
  v_mfma_f32_16x16x32_bf16 v[172:175], v[240:243], v[92:95], v[172:175]
  v_mfma_f32_16x16x32_bf16 v[172:175], v[244:247], v[96:99], v[172:175]
  v_mfma_f32_16x16x32_bf16 v[172:175], v[248:251], v[100:103], v[172:175]
  v_mfma_f32_16x16x32_bf16 v[172:175], v[252:255], v[104:107], v[172:175]
  s_waitcnt vmcnt(8)
  s_barrier
  s_waitcnt lgkmcnt(0)
  v_mfma_f32_16x16x32_bf16 v[168:171], a[240:243], v[108:111], v[168:171]
  ds_read_b128 v[48:51], v2 offset:57344
  v_mfma_f32_16x16x32_bf16 v[168:171], a[244:247], v[112:115], v[168:171]
  ds_read_b128 v[52:55], v2 offset:57408
  v_mfma_f32_16x16x32_bf16 v[168:171], a[248:251], v[116:119], v[168:171]
  ds_read_b128 v[56:59], v2 offset:57472
  v_mfma_f32_16x16x32_bf16 v[168:171], a[252:255], v[120:123], v[168:171]
  ds_read_b128 v[60:63], v3 offset:57344
  v_mfma_f32_16x16x32_bf16 v[168:171], v[212:215], v[124:127], v[168:171]
  ds_read_b128 v[64:67], v3 offset:57408
  v_mfma_f32_16x16x32_bf16 v[168:171], v[216:219], v[128:131], v[168:171]
  ds_read_b128 v[68:71], v3 offset:57472
  v_mfma_f32_16x16x32_bf16 v[168:171], v[220:223], v[132:135], v[168:171]
  ds_read_b128 v[72:75], v4 offset:57344
  v_mfma_f32_16x16x32_bf16 v[168:171], v[224:227], v[136:139], v[168:171]
  ds_read_b128 v[76:79], v4 offset:57408
  v_mfma_f32_16x16x32_bf16 v[168:171], v[228:231], v[140:143], v[168:171]
  ds_read_b128 v[80:83], v4 offset:57472
  v_mfma_f32_16x16x32_bf16 v[168:171], v[232:235], v[144:147], v[168:171]
  ds_read_b128 v[84:87], v5 offset:57344
  s_add_u32 s51, s50, 43008
  v_mfma_f32_16x16x32_bf16 v[168:171], v[236:239], v[148:151], v[168:171]
  ds_read_b128 v[88:91], v5 offset:57408
  v_cvt_pk_bf16_f32 v26, v172, v173
  v_mfma_f32_16x16x32_bf16 v[168:171], v[240:243], v[152:155], v[168:171]
  ds_read_b128 v[92:95], v5 offset:57472
  v_cvt_pk_bf16_f32 v27, v174, v175
  v_mfma_f32_16x16x32_bf16 v[168:171], v[244:247], v[156:159], v[168:171]
  ds_read_b128 v[96:99], v6 offset:57344
  buffer_store_dwordx2 v[26:27], v16, s[16:19], s51 offen nt
  v_mfma_f32_16x16x32_bf16 v[168:171], v[248:251], v[160:163], v[168:171]
  ds_read_b128 v[100:103], v6 offset:57408
  v_mfma_f32_16x16x32_bf16 v[168:171], v[252:255], v[164:167], v[168:171]
  ds_read_b128 v[104:107], v6 offset:57472
  s_waitcnt lgkmcnt(5)
  v_mfma_f32_16x16x32_bf16 v[184:187], a[0:3], v[48:51], v[184:187]
  ds_read_b128 v[108:111], v2 offset:64512
  v_mfma_f32_16x16x32_bf16 v[184:187], a[4:7], v[52:55], v[184:187]
  s_add_u32 s30, s26, 559104
  v_mfma_f32_16x16x32_bf16 v[184:187], a[8:11], v[56:59], v[184:187]
  s_sub_u32 s31, s30, 9633792
  v_mfma_f32_16x16x32_bf16 v[184:187], a[12:15], v[60:63], v[184:187]
  s_min_u32 s27, s30, s31
  v_mfma_f32_16x16x32_bf16 v[184:187], a[16:19], v[64:67], v[184:187]
  ds_read_b128 v[112:115], v2 offset:64576
  v_mfma_f32_16x16x32_bf16 v[184:187], a[20:23], v[68:71], v[184:187]
  s_add_u32 m0, s23, 93184
  v_mfma_f32_16x16x32_bf16 v[184:187], a[24:27], v[72:75], v[184:187]
  buffer_load_dwordx4 v12, s[8:11], s27 offen lds
  v_mfma_f32_16x16x32_bf16 v[184:187], a[28:31], v[76:79], v[184:187]
  s_and_b32 s32, s25, 93184
  v_mfma_f32_16x16x32_bf16 v[184:187], a[32:35], v[80:83], v[184:187]
  ds_read_b128 v[116:119], v2 offset:64640
  v_mfma_f32_16x16x32_bf16 v[184:187], a[36:39], v[84:87], v[184:187]
  s_add_u32 m0, s24, s32
  s_waitcnt lgkmcnt(1)
  v_mfma_f32_16x16x32_bf16 v[184:187], a[40:43], v[88:91], v[184:187]
  buffer_load_dwordx4 v13, s[8:11], s27 offen lds
  v_mfma_f32_16x16x32_bf16 v[184:187], a[44:47], v[92:95], v[184:187]
  s_add_u32 s30, s26, 602112
  v_mfma_f32_16x16x32_bf16 v[184:187], a[48:51], v[96:99], v[184:187]
  s_sub_u32 s31, s30, 9633792
  v_mfma_f32_16x16x32_bf16 v[184:187], a[52:55], v[100:103], v[184:187]
  ds_read_b128 v[120:123], v3 offset:64512
  v_mfma_f32_16x16x32_bf16 v[184:187], a[56:59], v[104:107], v[184:187]
  s_min_u32 s27, s30, s31
  v_mfma_f32_16x16x32_bf16 v[188:191], a[60:63], v[48:51], v[188:191]
  s_add_u32 m0, s23, 100352
  v_mfma_f32_16x16x32_bf16 v[188:191], a[64:67], v[52:55], v[188:191]
  buffer_load_dwordx4 v12, s[8:11], s27 offen lds
  v_mfma_f32_16x16x32_bf16 v[188:191], a[68:71], v[56:59], v[188:191]
  ds_read_b128 v[124:127], v3 offset:64576
  v_mfma_f32_16x16x32_bf16 v[188:191], a[72:75], v[60:63], v[188:191]
  s_and_b32 s32, s25, 100352
  v_mfma_f32_16x16x32_bf16 v[188:191], a[76:79], v[64:67], v[188:191]
  s_add_u32 m0, s24, s32
  v_mfma_f32_16x16x32_bf16 v[188:191], a[80:83], v[68:71], v[188:191]
  buffer_load_dwordx4 v13, s[8:11], s27 offen lds
  v_mfma_f32_16x16x32_bf16 v[188:191], a[84:87], v[72:75], v[188:191]
  s_mov_b32 s51, s50
  v_mfma_f32_16x16x32_bf16 v[188:191], a[88:91], v[76:79], v[188:191]
  ds_read_b128 v[128:131], v3 offset:64640
  v_mfma_f32_16x16x32_bf16 v[188:191], a[92:95], v[80:83], v[188:191]
  v_cvt_pk_bf16_f32 v24, v184, v185
  v_mfma_f32_16x16x32_bf16 v[188:191], a[96:99], v[84:87], v[188:191]
  v_cvt_pk_bf16_f32 v25, v186, v187
  v_mfma_f32_16x16x32_bf16 v[188:191], a[100:103], v[88:91], v[188:191]
  buffer_store_dwordx2 v[24:25], v16, s[16:19], s28 offen nt
  v_mfma_f32_16x16x32_bf16 v[188:191], a[104:107], v[92:95], v[188:191]
  ds_read_b128 v[132:135], v4 offset:64512
  v_mfma_f32_16x16x32_bf16 v[188:191], a[108:111], v[96:99], v[188:191]
  s_add_u32 s28, s28, 43008
  v_mfma_f32_16x16x32_bf16 v[188:191], a[112:115], v[100:103], v[188:191]
  v_cvt_pk_bf16_f32 v26, v168, v169
  v_mfma_f32_16x16x32_bf16 v[188:191], a[116:119], v[104:107], v[188:191]
  v_cvt_pk_bf16_f32 v27, v170, v171
  v_mfma_f32_16x16x32_bf16 v[192:195], a[120:123], v[48:51], v[192:195]
  ds_read_b128 v[136:139], v4 offset:64576
  v_mfma_f32_16x16x32_bf16 v[192:195], a[124:127], v[52:55], v[192:195]
  buffer_store_dwordx2 v[26:27], v16, s[16:19], s51 offen nt
  v_mfma_f32_16x16x32_bf16 v[192:195], a[128:131], v[56:59], v[192:195]
  v_mfma_f32_16x16x32_bf16 v[192:195], a[132:135], v[60:63], v[192:195]
  v_mfma_f32_16x16x32_bf16 v[192:195], a[136:139], v[64:67], v[192:195]
  v_mfma_f32_16x16x32_bf16 v[192:195], a[140:143], v[68:71], v[192:195]
  ds_read_b128 v[140:143], v4 offset:64640
  v_mfma_f32_16x16x32_bf16 v[192:195], a[144:147], v[72:75], v[192:195]
  v_mfma_f32_16x16x32_bf16 v[192:195], a[148:151], v[76:79], v[192:195]
  v_mfma_f32_16x16x32_bf16 v[192:195], a[152:155], v[80:83], v[192:195]
  v_mfma_f32_16x16x32_bf16 v[192:195], a[156:159], v[84:87], v[192:195]
  ds_read_b128 v[144:147], v5 offset:64512
  v_mfma_f32_16x16x32_bf16 v[192:195], a[160:163], v[88:91], v[192:195]
  v_mfma_f32_16x16x32_bf16 v[192:195], a[164:167], v[92:95], v[192:195]
  v_mfma_f32_16x16x32_bf16 v[192:195], a[168:171], v[96:99], v[192:195]
  v_mfma_f32_16x16x32_bf16 v[192:195], a[172:175], v[100:103], v[192:195]
  v_mfma_f32_16x16x32_bf16 v[192:195], a[176:179], v[104:107], v[192:195]
  ds_read_b128 v[148:151], v5 offset:64576
  v_mfma_f32_16x16x32_bf16 v[196:199], a[180:183], v[48:51], v[196:199]
  v_mfma_f32_16x16x32_bf16 v[196:199], a[184:187], v[52:55], v[196:199]
  v_mfma_f32_16x16x32_bf16 v[196:199], a[188:191], v[56:59], v[196:199]
  v_mfma_f32_16x16x32_bf16 v[196:199], a[192:195], v[60:63], v[196:199]
  ds_read_b128 v[152:155], v5 offset:64640
  v_mfma_f32_16x16x32_bf16 v[196:199], a[196:199], v[64:67], v[196:199]
  v_mfma_f32_16x16x32_bf16 v[196:199], a[200:203], v[68:71], v[196:199]
  v_mfma_f32_16x16x32_bf16 v[196:199], a[204:207], v[72:75], v[196:199]
  v_mfma_f32_16x16x32_bf16 v[196:199], a[208:211], v[76:79], v[196:199]
  ds_read_b128 v[156:159], v6 offset:64512
  v_mfma_f32_16x16x32_bf16 v[196:199], a[212:215], v[80:83], v[196:199]
  v_mfma_f32_16x16x32_bf16 v[196:199], a[216:219], v[84:87], v[196:199]
  v_mfma_f32_16x16x32_bf16 v[196:199], a[220:223], v[88:91], v[196:199]
  v_mfma_f32_16x16x32_bf16 v[196:199], a[224:227], v[92:95], v[196:199]
  v_mfma_f32_16x16x32_bf16 v[196:199], a[228:231], v[96:99], v[196:199]
  ds_read_b128 v[160:163], v6 offset:64576
  v_mfma_f32_16x16x32_bf16 v[196:199], a[232:235], v[100:103], v[196:199]
  v_mfma_f32_16x16x32_bf16 v[196:199], a[236:239], v[104:107], v[196:199]
  v_mfma_f32_16x16x32_bf16 v[32:35], a[240:243], v[48:51], 0
  v_mfma_f32_16x16x32_bf16 v[32:35], a[244:247], v[52:55], v[32:35]
  ds_read_b128 v[164:167], v6 offset:64640
  v_mfma_f32_16x16x32_bf16 v[32:35], a[248:251], v[56:59], v[32:35]
  v_mfma_f32_16x16x32_bf16 v[32:35], a[252:255], v[60:63], v[32:35]
  v_mfma_f32_16x16x32_bf16 v[32:35], v[212:215], v[64:67], v[32:35]
  v_mfma_f32_16x16x32_bf16 v[32:35], v[216:219], v[68:71], v[32:35]
  v_mfma_f32_16x16x32_bf16 v[32:35], v[220:223], v[72:75], v[32:35]
  v_mfma_f32_16x16x32_bf16 v[32:35], v[224:227], v[76:79], v[32:35]
  v_mfma_f32_16x16x32_bf16 v[32:35], v[228:231], v[80:83], v[32:35]
  v_mfma_f32_16x16x32_bf16 v[32:35], v[232:235], v[84:87], v[32:35]
  v_mfma_f32_16x16x32_bf16 v[32:35], v[236:239], v[88:91], v[32:35]
  v_mfma_f32_16x16x32_bf16 v[32:35], v[240:243], v[92:95], v[32:35]
  v_mfma_f32_16x16x32_bf16 v[32:35], v[244:247], v[96:99], v[32:35]
  s_waitcnt vmcnt(13)
  v_mfma_f32_16x16x32_bf16 v[32:35], v[248:251], v[100:103], v[32:35]
  s_waitcnt lgkmcnt(0)
  v_mfma_f32_16x16x32_bf16 v[32:35], v[252:255], v[104:107], v[32:35]
  s_barrier
  v_mfma_f32_16x16x32_bf16 v[188:191], a[0:3], v[108:111], v[188:191]
  ds_read_b128 v[48:51], v7 offset:0
  v_mfma_f32_16x16x32_bf16 v[188:191], a[4:7], v[112:115], v[188:191]
  s_add_u32 s30, s26, 645120
  v_mfma_f32_16x16x32_bf16 v[188:191], a[8:11], v[116:119], v[188:191]
  s_sub_u32 s31, s30, 9633792
  v_mfma_f32_16x16x32_bf16 v[188:191], a[12:15], v[120:123], v[188:191]
  s_min_u32 s27, s30, s31
  v_mfma_f32_16x16x32_bf16 v[188:191], a[16:19], v[124:127], v[188:191]
  ds_read_b128 v[52:55], v7 offset:64
  v_mfma_f32_16x16x32_bf16 v[188:191], a[20:23], v[128:131], v[188:191]
  s_add_u32 m0, s23, 107520
  v_mfma_f32_16x16x32_bf16 v[188:191], a[24:27], v[132:135], v[188:191]
  buffer_load_dwordx4 v12, s[8:11], s27 offen lds
  v_mfma_f32_16x16x32_bf16 v[188:191], a[28:31], v[136:139], v[188:191]
  s_and_b32 s32, s25, 107520
  v_mfma_f32_16x16x32_bf16 v[188:191], a[32:35], v[140:143], v[188:191]
  ds_read_b128 v[56:59], v7 offset:128
  v_mfma_f32_16x16x32_bf16 v[188:191], a[36:39], v[144:147], v[188:191]
  s_add_u32 m0, s24, s32
  v_mfma_f32_16x16x32_bf16 v[188:191], a[40:43], v[148:151], v[188:191]
  buffer_load_dwordx4 v13, s[8:11], s27 offen lds
  v_mfma_f32_16x16x32_bf16 v[188:191], a[44:47], v[152:155], v[188:191]
  v_mfma_f32_16x16x32_bf16 v[188:191], a[48:51], v[156:159], v[188:191]
  v_mfma_f32_16x16x32_bf16 v[188:191], a[52:55], v[160:163], v[188:191]
  ds_read_b128 v[60:63], v8 offset:0
  v_mfma_f32_16x16x32_bf16 v[188:191], a[56:59], v[164:167], v[188:191]
  v_mfma_f32_16x16x32_bf16 v[192:195], a[60:63], v[108:111], v[192:195]
  v_mfma_f32_16x16x32_bf16 v[192:195], a[64:67], v[112:115], v[192:195]
  v_mfma_f32_16x16x32_bf16 v[192:195], a[68:71], v[116:119], v[192:195]
  ds_read_b128 v[64:67], v8 offset:64
  v_mfma_f32_16x16x32_bf16 v[192:195], a[72:75], v[120:123], v[192:195]
  v_mfma_f32_16x16x32_bf16 v[192:195], a[76:79], v[124:127], v[192:195]
  v_mfma_f32_16x16x32_bf16 v[192:195], a[80:83], v[128:131], v[192:195]
  v_mfma_f32_16x16x32_bf16 v[192:195], a[84:87], v[132:135], v[192:195]
  v_mfma_f32_16x16x32_bf16 v[192:195], a[88:91], v[136:139], v[192:195]
  ds_read_b128 v[68:71], v8 offset:128
  v_mfma_f32_16x16x32_bf16 v[192:195], a[92:95], v[140:143], v[192:195]
  v_cvt_pk_bf16_f32 v24, v188, v189
  v_mfma_f32_16x16x32_bf16 v[192:195], a[96:99], v[144:147], v[192:195]
  v_cvt_pk_bf16_f32 v25, v190, v191
  v_mfma_f32_16x16x32_bf16 v[192:195], a[100:103], v[148:151], v[192:195]
  buffer_store_dwordx2 v[24:25], v16, s[16:19], s28 offen nt
  v_mfma_f32_16x16x32_bf16 v[192:195], a[104:107], v[152:155], v[192:195]
  ds_read_b128 v[72:75], v9 offset:0
  v_mfma_f32_16x16x32_bf16 v[192:195], a[108:111], v[156:159], v[192:195]
  s_add_u32 s28, s28, 43008
  v_mfma_f32_16x16x32_bf16 v[192:195], a[112:115], v[160:163], v[192:195]
  v_mfma_f32_16x16x32_bf16 v[192:195], a[116:119], v[164:167], v[192:195]
  v_mfma_f32_16x16x32_bf16 v[196:199], a[120:123], v[108:111], v[196:199]
  ds_read_b128 v[76:79], v9 offset:64
  v_mfma_f32_16x16x32_bf16 v[196:199], a[124:127], v[112:115], v[196:199]
  v_mfma_f32_16x16x32_bf16 v[196:199], a[128:131], v[116:119], v[196:199]
  v_mfma_f32_16x16x32_bf16 v[196:199], a[132:135], v[120:123], v[196:199]
  v_mfma_f32_16x16x32_bf16 v[196:199], a[136:139], v[124:127], v[196:199]
  v_mfma_f32_16x16x32_bf16 v[196:199], a[140:143], v[128:131], v[196:199]
  ds_read_b128 v[80:83], v9 offset:128
  v_mfma_f32_16x16x32_bf16 v[196:199], a[144:147], v[132:135], v[196:199]
  v_mfma_f32_16x16x32_bf16 v[196:199], a[148:151], v[136:139], v[196:199]
  v_mfma_f32_16x16x32_bf16 v[196:199], a[152:155], v[140:143], v[196:199]
  v_mfma_f32_16x16x32_bf16 v[196:199], a[156:159], v[144:147], v[196:199]
  ds_read_b128 v[84:87], v10 offset:0
  v_mfma_f32_16x16x32_bf16 v[196:199], a[160:163], v[148:151], v[196:199]
  v_mfma_f32_16x16x32_bf16 v[196:199], a[164:167], v[152:155], v[196:199]
  v_mfma_f32_16x16x32_bf16 v[196:199], a[168:171], v[156:159], v[196:199]
  v_mfma_f32_16x16x32_bf16 v[196:199], a[172:175], v[160:163], v[196:199]
  v_mfma_f32_16x16x32_bf16 v[196:199], a[176:179], v[164:167], v[196:199]
  ds_read_b128 v[88:91], v10 offset:64
  v_mfma_f32_16x16x32_bf16 v[32:35], a[180:183], v[108:111], v[32:35]
  v_mfma_f32_16x16x32_bf16 v[32:35], a[184:187], v[112:115], v[32:35]
  v_mfma_f32_16x16x32_bf16 v[32:35], a[188:191], v[116:119], v[32:35]
  v_mfma_f32_16x16x32_bf16 v[32:35], a[192:195], v[120:123], v[32:35]
  ds_read_b128 v[92:95], v10 offset:128
  v_mfma_f32_16x16x32_bf16 v[32:35], a[196:199], v[124:127], v[32:35]
  v_mfma_f32_16x16x32_bf16 v[32:35], a[200:203], v[128:131], v[32:35]
  v_mfma_f32_16x16x32_bf16 v[32:35], a[204:207], v[132:135], v[32:35]
  v_mfma_f32_16x16x32_bf16 v[32:35], a[208:211], v[136:139], v[32:35]
  ds_read_b128 v[96:99], v11 offset:0
  v_mfma_f32_16x16x32_bf16 v[32:35], a[212:215], v[140:143], v[32:35]
  v_mfma_f32_16x16x32_bf16 v[32:35], a[216:219], v[144:147], v[32:35]
  v_mfma_f32_16x16x32_bf16 v[32:35], a[220:223], v[148:151], v[32:35]
  v_mfma_f32_16x16x32_bf16 v[32:35], a[224:227], v[152:155], v[32:35]
  v_mfma_f32_16x16x32_bf16 v[32:35], a[228:231], v[156:159], v[32:35]
  ds_read_b128 v[100:103], v11 offset:64
  v_mfma_f32_16x16x32_bf16 v[32:35], a[232:235], v[160:163], v[32:35]
  v_mfma_f32_16x16x32_bf16 v[32:35], a[236:239], v[164:167], v[32:35]
  v_mfma_f32_16x16x32_bf16 v[36:39], a[240:243], v[108:111], 0
  v_mfma_f32_16x16x32_bf16 v[36:39], a[244:247], v[112:115], v[36:39]
  ds_read_b128 v[104:107], v11 offset:128
  v_mfma_f32_16x16x32_bf16 v[36:39], a[248:251], v[116:119], v[36:39]
  v_mfma_f32_16x16x32_bf16 v[36:39], a[252:255], v[120:123], v[36:39]
  v_mfma_f32_16x16x32_bf16 v[36:39], v[212:215], v[124:127], v[36:39]
  v_mfma_f32_16x16x32_bf16 v[36:39], v[216:219], v[128:131], v[36:39]
  v_mfma_f32_16x16x32_bf16 v[36:39], v[220:223], v[132:135], v[36:39]
  v_mfma_f32_16x16x32_bf16 v[36:39], v[224:227], v[136:139], v[36:39]
  v_mfma_f32_16x16x32_bf16 v[36:39], v[228:231], v[140:143], v[36:39]
  v_mfma_f32_16x16x32_bf16 v[36:39], v[232:235], v[144:147], v[36:39]
  v_mfma_f32_16x16x32_bf16 v[36:39], v[236:239], v[148:151], v[36:39]
  v_mfma_f32_16x16x32_bf16 v[36:39], v[240:243], v[152:155], v[36:39]
  v_mfma_f32_16x16x32_bf16 v[36:39], v[244:247], v[156:159], v[36:39]
  s_waitcnt vmcnt(14)
  v_mfma_f32_16x16x32_bf16 v[36:39], v[248:251], v[160:163], v[36:39]
  s_waitcnt lgkmcnt(0)
  v_mfma_f32_16x16x32_bf16 v[36:39], v[252:255], v[164:167], v[36:39]
  s_barrier
  v_mfma_f32_16x16x32_bf16 v[192:195], a[0:3], v[48:51], v[192:195]
  ds_read_b128 v[108:111], v7 offset:7168
  v_mfma_f32_16x16x32_bf16 v[192:195], a[4:7], v[52:55], v[192:195]
  v_mfma_f32_16x16x32_bf16 v[192:195], a[8:11], v[56:59], v[192:195]
  v_mfma_f32_16x16x32_bf16 v[192:195], a[12:15], v[60:63], v[192:195]
  v_mfma_f32_16x16x32_bf16 v[192:195], a[16:19], v[64:67], v[192:195]
  ds_read_b128 v[112:115], v7 offset:7232
  v_mfma_f32_16x16x32_bf16 v[192:195], a[20:23], v[68:71], v[192:195]
  v_mfma_f32_16x16x32_bf16 v[192:195], a[24:27], v[72:75], v[192:195]
  v_mfma_f32_16x16x32_bf16 v[192:195], a[28:31], v[76:79], v[192:195]
  v_mfma_f32_16x16x32_bf16 v[192:195], a[32:35], v[80:83], v[192:195]
  ds_read_b128 v[116:119], v7 offset:7296
  v_mfma_f32_16x16x32_bf16 v[192:195], a[36:39], v[84:87], v[192:195]
  v_mfma_f32_16x16x32_bf16 v[192:195], a[40:43], v[88:91], v[192:195]
  v_mfma_f32_16x16x32_bf16 v[192:195], a[44:47], v[92:95], v[192:195]
  v_mfma_f32_16x16x32_bf16 v[192:195], a[48:51], v[96:99], v[192:195]
  v_mfma_f32_16x16x32_bf16 v[192:195], a[52:55], v[100:103], v[192:195]
  ds_read_b128 v[120:123], v8 offset:7168
  v_mfma_f32_16x16x32_bf16 v[192:195], a[56:59], v[104:107], v[192:195]
  v_mfma_f32_16x16x32_bf16 v[196:199], a[60:63], v[48:51], v[196:199]
  v_mfma_f32_16x16x32_bf16 v[196:199], a[64:67], v[52:55], v[196:199]
  v_mfma_f32_16x16x32_bf16 v[196:199], a[68:71], v[56:59], v[196:199]
  ds_read_b128 v[124:127], v8 offset:7232
  v_mfma_f32_16x16x32_bf16 v[196:199], a[72:75], v[60:63], v[196:199]
  v_mfma_f32_16x16x32_bf16 v[196:199], a[76:79], v[64:67], v[196:199]
  v_mfma_f32_16x16x32_bf16 v[196:199], a[80:83], v[68:71], v[196:199]
  v_mfma_f32_16x16x32_bf16 v[196:199], a[84:87], v[72:75], v[196:199]
  v_mfma_f32_16x16x32_bf16 v[196:199], a[88:91], v[76:79], v[196:199]
  ds_read_b128 v[128:131], v8 offset:7296
  v_mfma_f32_16x16x32_bf16 v[196:199], a[92:95], v[80:83], v[196:199]
  v_cvt_pk_bf16_f32 v24, v192, v193
  v_mfma_f32_16x16x32_bf16 v[196:199], a[96:99], v[84:87], v[196:199]
  v_cvt_pk_bf16_f32 v25, v194, v195
  v_mfma_f32_16x16x32_bf16 v[196:199], a[100:103], v[88:91], v[196:199]
  buffer_store_dwordx2 v[24:25], v16, s[16:19], s28 offen nt
  v_mfma_f32_16x16x32_bf16 v[196:199], a[104:107], v[92:95], v[196:199]
  ds_read_b128 v[132:135], v9 offset:7168
  v_mfma_f32_16x16x32_bf16 v[196:199], a[108:111], v[96:99], v[196:199]
  s_add_u32 s28, s28, 43008
  v_mfma_f32_16x16x32_bf16 v[196:199], a[112:115], v[100:103], v[196:199]
  v_mfma_f32_16x16x32_bf16 v[196:199], a[116:119], v[104:107], v[196:199]
  v_mfma_f32_16x16x32_bf16 v[32:35], a[120:123], v[48:51], v[32:35]
  ds_read_b128 v[136:139], v9 offset:7232
  v_mfma_f32_16x16x32_bf16 v[32:35], a[124:127], v[52:55], v[32:35]
  v_mfma_f32_16x16x32_bf16 v[32:35], a[128:131], v[56:59], v[32:35]
  v_mfma_f32_16x16x32_bf16 v[32:35], a[132:135], v[60:63], v[32:35]
  v_mfma_f32_16x16x32_bf16 v[32:35], a[136:139], v[64:67], v[32:35]
  v_mfma_f32_16x16x32_bf16 v[32:35], a[140:143], v[68:71], v[32:35]
  ds_read_b128 v[140:143], v9 offset:7296
  v_mfma_f32_16x16x32_bf16 v[32:35], a[144:147], v[72:75], v[32:35]
  v_mfma_f32_16x16x32_bf16 v[32:35], a[148:151], v[76:79], v[32:35]
  v_mfma_f32_16x16x32_bf16 v[32:35], a[152:155], v[80:83], v[32:35]
  v_mfma_f32_16x16x32_bf16 v[32:35], a[156:159], v[84:87], v[32:35]
  ds_read_b128 v[144:147], v10 offset:7168
  v_mfma_f32_16x16x32_bf16 v[32:35], a[160:163], v[88:91], v[32:35]
  v_mfma_f32_16x16x32_bf16 v[32:35], a[164:167], v[92:95], v[32:35]
  v_mfma_f32_16x16x32_bf16 v[32:35], a[168:171], v[96:99], v[32:35]
  v_mfma_f32_16x16x32_bf16 v[32:35], a[172:175], v[100:103], v[32:35]
  v_mfma_f32_16x16x32_bf16 v[32:35], a[176:179], v[104:107], v[32:35]
  ds_read_b128 v[148:151], v10 offset:7232
  v_mfma_f32_16x16x32_bf16 v[36:39], a[180:183], v[48:51], v[36:39]
  v_mfma_f32_16x16x32_bf16 v[36:39], a[184:187], v[52:55], v[36:39]
  v_mfma_f32_16x16x32_bf16 v[36:39], a[188:191], v[56:59], v[36:39]
  v_mfma_f32_16x16x32_bf16 v[36:39], a[192:195], v[60:63], v[36:39]
  ds_read_b128 v[152:155], v10 offset:7296
  v_mfma_f32_16x16x32_bf16 v[36:39], a[196:199], v[64:67], v[36:39]
  v_mfma_f32_16x16x32_bf16 v[36:39], a[200:203], v[68:71], v[36:39]
  v_mfma_f32_16x16x32_bf16 v[36:39], a[204:207], v[72:75], v[36:39]
  v_mfma_f32_16x16x32_bf16 v[36:39], a[208:211], v[76:79], v[36:39]
  ds_read_b128 v[156:159], v11 offset:7168
  v_mfma_f32_16x16x32_bf16 v[36:39], a[212:215], v[80:83], v[36:39]
  v_mfma_f32_16x16x32_bf16 v[36:39], a[216:219], v[84:87], v[36:39]
  v_mfma_f32_16x16x32_bf16 v[36:39], a[220:223], v[88:91], v[36:39]
  v_mfma_f32_16x16x32_bf16 v[36:39], a[224:227], v[92:95], v[36:39]
  v_mfma_f32_16x16x32_bf16 v[36:39], a[228:231], v[96:99], v[36:39]
  ds_read_b128 v[160:163], v11 offset:7232
  v_mfma_f32_16x16x32_bf16 v[36:39], a[232:235], v[100:103], v[36:39]
  v_mfma_f32_16x16x32_bf16 v[36:39], a[236:239], v[104:107], v[36:39]
  v_mfma_f32_16x16x32_bf16 v[40:43], a[240:243], v[48:51], 0
  v_mfma_f32_16x16x32_bf16 v[40:43], a[244:247], v[52:55], v[40:43]
  ds_read_b128 v[164:167], v11 offset:7296
  v_mfma_f32_16x16x32_bf16 v[40:43], a[248:251], v[56:59], v[40:43]
  v_mfma_f32_16x16x32_bf16 v[40:43], a[252:255], v[60:63], v[40:43]
  v_mfma_f32_16x16x32_bf16 v[40:43], v[212:215], v[64:67], v[40:43]
  v_mfma_f32_16x16x32_bf16 v[40:43], v[216:219], v[68:71], v[40:43]
  v_mfma_f32_16x16x32_bf16 v[40:43], v[220:223], v[72:75], v[40:43]
  v_mfma_f32_16x16x32_bf16 v[40:43], v[224:227], v[76:79], v[40:43]
  v_mfma_f32_16x16x32_bf16 v[40:43], v[228:231], v[80:83], v[40:43]
  v_mfma_f32_16x16x32_bf16 v[40:43], v[232:235], v[84:87], v[40:43]
  v_mfma_f32_16x16x32_bf16 v[40:43], v[236:239], v[88:91], v[40:43]
  v_mfma_f32_16x16x32_bf16 v[40:43], v[240:243], v[92:95], v[40:43]
  v_mfma_f32_16x16x32_bf16 v[40:43], v[244:247], v[96:99], v[40:43]
  s_waitcnt vmcnt(13)
  v_mfma_f32_16x16x32_bf16 v[40:43], v[248:251], v[100:103], v[40:43]
  s_waitcnt lgkmcnt(0)
  v_mfma_f32_16x16x32_bf16 v[40:43], v[252:255], v[104:107], v[40:43]
  s_barrier
  v_mfma_f32_16x16x32_bf16 v[196:199], a[0:3], v[108:111], v[196:199]
  ds_read_b128 v[48:51], v7 offset:14336
  v_mfma_f32_16x16x32_bf16 v[196:199], a[4:7], v[112:115], v[196:199]
  v_mfma_f32_16x16x32_bf16 v[196:199], a[8:11], v[116:119], v[196:199]
  v_mfma_f32_16x16x32_bf16 v[196:199], a[12:15], v[120:123], v[196:199]
  v_mfma_f32_16x16x32_bf16 v[196:199], a[16:19], v[124:127], v[196:199]
  ds_read_b128 v[52:55], v7 offset:14400
  v_mfma_f32_16x16x32_bf16 v[196:199], a[20:23], v[128:131], v[196:199]
  v_mfma_f32_16x16x32_bf16 v[196:199], a[24:27], v[132:135], v[196:199]
  v_mfma_f32_16x16x32_bf16 v[196:199], a[28:31], v[136:139], v[196:199]
  v_mfma_f32_16x16x32_bf16 v[196:199], a[32:35], v[140:143], v[196:199]
  ds_read_b128 v[56:59], v7 offset:14464
  v_mfma_f32_16x16x32_bf16 v[196:199], a[36:39], v[144:147], v[196:199]
  v_mfma_f32_16x16x32_bf16 v[196:199], a[40:43], v[148:151], v[196:199]
  v_mfma_f32_16x16x32_bf16 v[196:199], a[44:47], v[152:155], v[196:199]
  v_mfma_f32_16x16x32_bf16 v[196:199], a[48:51], v[156:159], v[196:199]
  v_mfma_f32_16x16x32_bf16 v[196:199], a[52:55], v[160:163], v[196:199]
  ds_read_b128 v[60:63], v8 offset:14336
  v_mfma_f32_16x16x32_bf16 v[196:199], a[56:59], v[164:167], v[196:199]
  v_mfma_f32_16x16x32_bf16 v[32:35], a[60:63], v[108:111], v[32:35]
  v_mfma_f32_16x16x32_bf16 v[32:35], a[64:67], v[112:115], v[32:35]
  v_mfma_f32_16x16x32_bf16 v[32:35], a[68:71], v[116:119], v[32:35]
  ds_read_b128 v[64:67], v8 offset:14400
  v_mfma_f32_16x16x32_bf16 v[32:35], a[72:75], v[120:123], v[32:35]
  v_mfma_f32_16x16x32_bf16 v[32:35], a[76:79], v[124:127], v[32:35]
  v_mfma_f32_16x16x32_bf16 v[32:35], a[80:83], v[128:131], v[32:35]
  v_mfma_f32_16x16x32_bf16 v[32:35], a[84:87], v[132:135], v[32:35]
  v_mfma_f32_16x16x32_bf16 v[32:35], a[88:91], v[136:139], v[32:35]
  ds_read_b128 v[68:71], v8 offset:14464
  v_mfma_f32_16x16x32_bf16 v[32:35], a[92:95], v[140:143], v[32:35]
  v_cvt_pk_bf16_f32 v24, v196, v197
  v_mfma_f32_16x16x32_bf16 v[32:35], a[96:99], v[144:147], v[32:35]
  v_cvt_pk_bf16_f32 v25, v198, v199
  v_mfma_f32_16x16x32_bf16 v[32:35], a[100:103], v[148:151], v[32:35]
  buffer_store_dwordx2 v[24:25], v16, s[16:19], s28 offen nt
  v_mfma_f32_16x16x32_bf16 v[32:35], a[104:107], v[152:155], v[32:35]
  ds_read_b128 v[72:75], v9 offset:14336
  v_mfma_f32_16x16x32_bf16 v[32:35], a[108:111], v[156:159], v[32:35]
  s_add_u32 s28, s28, 43008
  v_mfma_f32_16x16x32_bf16 v[32:35], a[112:115], v[160:163], v[32:35]
  v_mfma_f32_16x16x32_bf16 v[32:35], a[116:119], v[164:167], v[32:35]
  v_mfma_f32_16x16x32_bf16 v[36:39], a[120:123], v[108:111], v[36:39]
  ds_read_b128 v[76:79], v9 offset:14400
  v_mfma_f32_16x16x32_bf16 v[36:39], a[124:127], v[112:115], v[36:39]
  v_mfma_f32_16x16x32_bf16 v[36:39], a[128:131], v[116:119], v[36:39]
  v_mfma_f32_16x16x32_bf16 v[36:39], a[132:135], v[120:123], v[36:39]
  v_mfma_f32_16x16x32_bf16 v[36:39], a[136:139], v[124:127], v[36:39]
  v_mfma_f32_16x16x32_bf16 v[36:39], a[140:143], v[128:131], v[36:39]
  ds_read_b128 v[80:83], v9 offset:14464
  v_mfma_f32_16x16x32_bf16 v[36:39], a[144:147], v[132:135], v[36:39]
  v_mfma_f32_16x16x32_bf16 v[36:39], a[148:151], v[136:139], v[36:39]
  v_mfma_f32_16x16x32_bf16 v[36:39], a[152:155], v[140:143], v[36:39]
  v_mfma_f32_16x16x32_bf16 v[36:39], a[156:159], v[144:147], v[36:39]
  ds_read_b128 v[84:87], v10 offset:14336
  v_mfma_f32_16x16x32_bf16 v[36:39], a[160:163], v[148:151], v[36:39]
  v_mfma_f32_16x16x32_bf16 v[36:39], a[164:167], v[152:155], v[36:39]
  v_mfma_f32_16x16x32_bf16 v[36:39], a[168:171], v[156:159], v[36:39]
  v_mfma_f32_16x16x32_bf16 v[36:39], a[172:175], v[160:163], v[36:39]
  v_mfma_f32_16x16x32_bf16 v[36:39], a[176:179], v[164:167], v[36:39]
  ds_read_b128 v[88:91], v10 offset:14400
  v_mfma_f32_16x16x32_bf16 v[40:43], a[180:183], v[108:111], v[40:43]
  v_mfma_f32_16x16x32_bf16 v[40:43], a[184:187], v[112:115], v[40:43]
  v_mfma_f32_16x16x32_bf16 v[40:43], a[188:191], v[116:119], v[40:43]
  v_mfma_f32_16x16x32_bf16 v[40:43], a[192:195], v[120:123], v[40:43]
  ds_read_b128 v[92:95], v10 offset:14464
  v_mfma_f32_16x16x32_bf16 v[40:43], a[196:199], v[124:127], v[40:43]
  v_mfma_f32_16x16x32_bf16 v[40:43], a[200:203], v[128:131], v[40:43]
  v_mfma_f32_16x16x32_bf16 v[40:43], a[204:207], v[132:135], v[40:43]
  v_mfma_f32_16x16x32_bf16 v[40:43], a[208:211], v[136:139], v[40:43]
  ds_read_b128 v[96:99], v11 offset:14336
  v_mfma_f32_16x16x32_bf16 v[40:43], a[212:215], v[140:143], v[40:43]
  v_mfma_f32_16x16x32_bf16 v[40:43], a[216:219], v[144:147], v[40:43]
  v_mfma_f32_16x16x32_bf16 v[40:43], a[220:223], v[148:151], v[40:43]
  v_mfma_f32_16x16x32_bf16 v[40:43], a[224:227], v[152:155], v[40:43]
  v_mfma_f32_16x16x32_bf16 v[40:43], a[228:231], v[156:159], v[40:43]
  ds_read_b128 v[100:103], v11 offset:14400
  v_mfma_f32_16x16x32_bf16 v[40:43], a[232:235], v[160:163], v[40:43]
  v_mfma_f32_16x16x32_bf16 v[40:43], a[236:239], v[164:167], v[40:43]
  v_mfma_f32_16x16x32_bf16 v[44:47], a[240:243], v[108:111], 0
  v_mfma_f32_16x16x32_bf16 v[44:47], a[244:247], v[112:115], v[44:47]
  ds_read_b128 v[104:107], v11 offset:14464
  v_mfma_f32_16x16x32_bf16 v[44:47], a[248:251], v[116:119], v[44:47]
  v_mfma_f32_16x16x32_bf16 v[44:47], a[252:255], v[120:123], v[44:47]
  v_mfma_f32_16x16x32_bf16 v[44:47], v[212:215], v[124:127], v[44:47]
  v_mfma_f32_16x16x32_bf16 v[44:47], v[216:219], v[128:131], v[44:47]
  v_mfma_f32_16x16x32_bf16 v[44:47], v[220:223], v[132:135], v[44:47]
  v_mfma_f32_16x16x32_bf16 v[44:47], v[224:227], v[136:139], v[44:47]
  v_mfma_f32_16x16x32_bf16 v[44:47], v[228:231], v[140:143], v[44:47]
  v_mfma_f32_16x16x32_bf16 v[44:47], v[232:235], v[144:147], v[44:47]
  v_mfma_f32_16x16x32_bf16 v[44:47], v[236:239], v[148:151], v[44:47]
  v_mfma_f32_16x16x32_bf16 v[44:47], v[240:243], v[152:155], v[44:47]
  v_mfma_f32_16x16x32_bf16 v[44:47], v[244:247], v[156:159], v[44:47]
  s_waitcnt vmcnt(9)
  v_mfma_f32_16x16x32_bf16 v[44:47], v[248:251], v[160:163], v[44:47]
  s_waitcnt lgkmcnt(0)
  v_mfma_f32_16x16x32_bf16 v[44:47], v[252:255], v[164:167], v[44:47]
  s_add_u32 s30, s26, 688128
  s_sub_u32 s31, s30, 9633792
  s_min_u32 s27, s30, s31
  s_mov_b32 s29, 1
.p2align 3
L_loop:
  s_barrier
  v_mfma_f32_16x16x32_bf16 v[32:35], a[0:3], v[48:51], v[32:35]
  ds_read_b128 v[108:111], v7 offset:21504
  v_mfma_f32_16x16x32_bf16 v[32:35], a[4:7], v[52:55], v[32:35]
  v_mfma_f32_16x16x32_bf16 v[32:35], a[8:11], v[56:59], v[32:35]
  v_mfma_f32_16x16x32_bf16 v[32:35], a[12:15], v[60:63], v[32:35]
  v_mfma_f32_16x16x32_bf16 v[32:35], a[16:19], v[64:67], v[32:35]
  ds_read_b128 v[112:115], v7 offset:21568
  v_mfma_f32_16x16x32_bf16 v[32:35], a[20:23], v[68:71], v[32:35]
  v_mfma_f32_16x16x32_bf16 v[32:35], a[24:27], v[72:75], v[32:35]
  v_mfma_f32_16x16x32_bf16 v[32:35], a[28:31], v[76:79], v[32:35]
  v_mfma_f32_16x16x32_bf16 v[32:35], a[32:35], v[80:83], v[32:35]
  ds_read_b128 v[116:119], v7 offset:21632
  v_mfma_f32_16x16x32_bf16 v[32:35], a[36:39], v[84:87], v[32:35]
  v_mfma_f32_16x16x32_bf16 v[32:35], a[40:43], v[88:91], v[32:35]
  v_mfma_f32_16x16x32_bf16 v[32:35], a[44:47], v[92:95], v[32:35]
  v_mfma_f32_16x16x32_bf16 v[32:35], a[48:51], v[96:99], v[32:35]
  v_mfma_f32_16x16x32_bf16 v[32:35], a[52:55], v[100:103], v[32:35]
  ds_read_b128 v[120:123], v8 offset:21504
  v_mfma_f32_16x16x32_bf16 v[32:35], a[56:59], v[104:107], v[32:35]
  v_mfma_f32_16x16x32_bf16 v[36:39], a[60:63], v[48:51], v[36:39]
  v_mfma_f32_16x16x32_bf16 v[36:39], a[64:67], v[52:55], v[36:39]
  v_mfma_f32_16x16x32_bf16 v[36:39], a[68:71], v[56:59], v[36:39]
  ds_read_b128 v[124:127], v8 offset:21568
  v_mfma_f32_16x16x32_bf16 v[36:39], a[72:75], v[60:63], v[36:39]
  s_add_u32 m0, s23, 86016
  v_mfma_f32_16x16x32_bf16 v[36:39], a[76:79], v[64:67], v[36:39]
  v_mfma_f32_16x16x32_bf16 v[36:39], a[80:83], v[68:71], v[36:39]
  buffer_load_dwordx4 v12, s[8:11], s27 offen lds
  v_mfma_f32_16x16x32_bf16 v[36:39], a[84:87], v[72:75], v[36:39]
  v_mfma_f32_16x16x32_bf16 v[36:39], a[88:91], v[76:79], v[36:39]
  ds_read_b128 v[128:131], v8 offset:21632
  v_mfma_f32_16x16x32_bf16 v[36:39], a[92:95], v[80:83], v[36:39]
  s_and_b32 s32, s25, 86016
  v_mfma_f32_16x16x32_bf16 v[36:39], a[96:99], v[84:87], v[36:39]
  v_cvt_pk_bf16_f32 v24, v32, v33
  v_mfma_f32_16x16x32_bf16 v[36:39], a[100:103], v[88:91], v[36:39]
  s_add_u32 m0, s24, s32
  v_mfma_f32_16x16x32_bf16 v[36:39], a[104:107], v[92:95], v[36:39]
  ds_read_b128 v[132:135], v9 offset:21504
  v_mfma_f32_16x16x32_bf16 v[36:39], a[108:111], v[96:99], v[36:39]
  buffer_load_dwordx4 v13, s[8:11], s27 offen lds
  v_mfma_f32_16x16x32_bf16 v[36:39], a[112:115], v[100:103], v[36:39]
  v_cvt_pk_bf16_f32 v25, v34, v35
  v_mfma_f32_16x16x32_bf16 v[36:39], a[116:119], v[104:107], v[36:39]
  s_add_u32 s27, s27, 43008
  v_mfma_f32_16x16x32_bf16 v[40:43], a[120:123], v[48:51], v[40:43]
  ds_read_b128 v[136:139], v9 offset:21568
  v_mfma_f32_16x16x32_bf16 v[40:43], a[124:127], v[52:55], v[40:43]
  s_sub_u32 s31, s27, 9633792
  v_mfma_f32_16x16x32_bf16 v[40:43], a[128:131], v[56:59], v[40:43]
  buffer_store_dwordx2 v[24:25], v16, s[16:19], s28 offen nt
  v_mfma_f32_16x16x32_bf16 v[40:43], a[132:135], v[60:63], v[40:43]
  s_min_u32 s27, s27, s31
  v_mfma_f32_16x16x32_bf16 v[40:43], a[136:139], v[64:67], v[40:43]
  s_add_u32 s28, s28, 43008
  v_mfma_f32_16x16x32_bf16 v[40:43], a[140:143], v[68:71], v[40:43]
  ds_read_b128 v[140:143], v9 offset:21632
  v_mfma_f32_16x16x32_bf16 v[40:43], a[144:147], v[72:75], v[40:43]
  v_mfma_f32_16x16x32_bf16 v[40:43], a[148:151], v[76:79], v[40:43]
  v_mfma_f32_16x16x32_bf16 v[40:43], a[152:155], v[80:83], v[40:43]
  v_mfma_f32_16x16x32_bf16 v[40:43], a[156:159], v[84:87], v[40:43]
  ds_read_b128 v[144:147], v10 offset:21504
  v_mfma_f32_16x16x32_bf16 v[40:43], a[160:163], v[88:91], v[40:43]
  v_mfma_f32_16x16x32_bf16 v[40:43], a[164:167], v[92:95], v[40:43]
  v_mfma_f32_16x16x32_bf16 v[40:43], a[168:171], v[96:99], v[40:43]
  v_mfma_f32_16x16x32_bf16 v[40:43], a[172:175], v[100:103], v[40:43]
  v_mfma_f32_16x16x32_bf16 v[40:43], a[176:179], v[104:107], v[40:43]
  ds_read_b128 v[148:151], v10 offset:21568
  v_mfma_f32_16x16x32_bf16 v[44:47], a[180:183], v[48:51], v[44:47]
  v_mfma_f32_16x16x32_bf16 v[44:47], a[184:187], v[52:55], v[44:47]
  v_mfma_f32_16x16x32_bf16 v[44:47], a[188:191], v[56:59], v[44:47]
  v_mfma_f32_16x16x32_bf16 v[44:47], a[192:195], v[60:63], v[44:47]
  ds_read_b128 v[152:155], v10 offset:21632
  v_mfma_f32_16x16x32_bf16 v[44:47], a[196:199], v[64:67], v[44:47]
  v_mfma_f32_16x16x32_bf16 v[44:47], a[200:203], v[68:71], v[44:47]
  v_mfma_f32_16x16x32_bf16 v[44:47], a[204:207], v[72:75], v[44:47]
  v_mfma_f32_16x16x32_bf16 v[44:47], a[208:211], v[76:79], v[44:47]
  ds_read_b128 v[156:159], v11 offset:21504
  v_mfma_f32_16x16x32_bf16 v[44:47], a[212:215], v[80:83], v[44:47]
  v_mfma_f32_16x16x32_bf16 v[44:47], a[216:219], v[84:87], v[44:47]
  v_mfma_f32_16x16x32_bf16 v[44:47], a[220:223], v[88:91], v[44:47]
  v_mfma_f32_16x16x32_bf16 v[44:47], a[224:227], v[92:95], v[44:47]
  v_mfma_f32_16x16x32_bf16 v[44:47], a[228:231], v[96:99], v[44:47]
  ds_read_b128 v[160:163], v11 offset:21568
  v_mfma_f32_16x16x32_bf16 v[44:47], a[232:235], v[100:103], v[44:47]
  v_mfma_f32_16x16x32_bf16 v[44:47], a[236:239], v[104:107], v[44:47]
  v_mfma_f32_16x16x32_bf16 v[32:35], a[240:243], v[48:51], 0
  v_mfma_f32_16x16x32_bf16 v[32:35], a[244:247], v[52:55], v[32:35]
  ds_read_b128 v[164:167], v11 offset:21632
  v_mfma_f32_16x16x32_bf16 v[32:35], a[248:251], v[56:59], v[32:35]
  v_mfma_f32_16x16x32_bf16 v[32:35], a[252:255], v[60:63], v[32:35]
  v_mfma_f32_16x16x32_bf16 v[32:35], v[212:215], v[64:67], v[32:35]
  v_mfma_f32_16x16x32_bf16 v[32:35], v[216:219], v[68:71], v[32:35]
  v_mfma_f32_16x16x32_bf16 v[32:35], v[220:223], v[72:75], v[32:35]
  v_mfma_f32_16x16x32_bf16 v[32:35], v[224:227], v[76:79], v[32:35]
  v_mfma_f32_16x16x32_bf16 v[32:35], v[228:231], v[80:83], v[32:35]
  v_mfma_f32_16x16x32_bf16 v[32:35], v[232:235], v[84:87], v[32:35]
  v_mfma_f32_16x16x32_bf16 v[32:35], v[236:239], v[88:91], v[32:35]
  v_mfma_f32_16x16x32_bf16 v[32:35], v[240:243], v[92:95], v[32:35]
  v_mfma_f32_16x16x32_bf16 v[32:35], v[244:247], v[96:99], v[32:35]
  s_waitcnt vmcnt(7)
  v_mfma_f32_16x16x32_bf16 v[32:35], v[248:251], v[100:103], v[32:35]
  s_waitcnt lgkmcnt(0)
  v_mfma_f32_16x16x32_bf16 v[32:35], v[252:255], v[104:107], v[32:35]
  s_barrier
  v_mfma_f32_16x16x32_bf16 v[36:39], a[0:3], v[108:111], v[36:39]
  ds_read_b128 v[48:51], v7 offset:28672
  v_mfma_f32_16x16x32_bf16 v[36:39], a[4:7], v[112:115], v[36:39]
  v_mfma_f32_16x16x32_bf16 v[36:39], a[8:11], v[116:119], v[36:39]
  v_mfma_f32_16x16x32_bf16 v[36:39], a[12:15], v[120:123], v[36:39]
  v_mfma_f32_16x16x32_bf16 v[36:39], a[16:19], v[124:127], v[36:39]
  ds_read_b128 v[52:55], v7 offset:28736
  v_mfma_f32_16x16x32_bf16 v[36:39], a[20:23], v[128:131], v[36:39]
  v_mfma_f32_16x16x32_bf16 v[36:39], a[24:27], v[132:135], v[36:39]
  v_mfma_f32_16x16x32_bf16 v[36:39], a[28:31], v[136:139], v[36:39]
  v_mfma_f32_16x16x32_bf16 v[36:39], a[32:35], v[140:143], v[36:39]
  ds_read_b128 v[56:59], v7 offset:28800
  v_mfma_f32_16x16x32_bf16 v[36:39], a[36:39], v[144:147], v[36:39]
  v_mfma_f32_16x16x32_bf16 v[36:39], a[40:43], v[148:151], v[36:39]
  v_mfma_f32_16x16x32_bf16 v[36:39], a[44:47], v[152:155], v[36:39]
  v_mfma_f32_16x16x32_bf16 v[36:39], a[48:51], v[156:159], v[36:39]
  v_mfma_f32_16x16x32_bf16 v[36:39], a[52:55], v[160:163], v[36:39]
  ds_read_b128 v[60:63], v8 offset:28672
  v_mfma_f32_16x16x32_bf16 v[36:39], a[56:59], v[164:167], v[36:39]
  v_mfma_f32_16x16x32_bf16 v[40:43], a[60:63], v[108:111], v[40:43]
  v_mfma_f32_16x16x32_bf16 v[40:43], a[64:67], v[112:115], v[40:43]
  v_mfma_f32_16x16x32_bf16 v[40:43], a[68:71], v[116:119], v[40:43]
  ds_read_b128 v[64:67], v8 offset:28736
  v_mfma_f32_16x16x32_bf16 v[40:43], a[72:75], v[120:123], v[40:43]
  s_add_u32 m0, s23, 93184
  v_mfma_f32_16x16x32_bf16 v[40:43], a[76:79], v[124:127], v[40:43]
  v_mfma_f32_16x16x32_bf16 v[40:43], a[80:83], v[128:131], v[40:43]
  buffer_load_dwordx4 v12, s[8:11], s27 offen lds
  v_mfma_f32_16x16x32_bf16 v[40:43], a[84:87], v[132:135], v[40:43]
  v_mfma_f32_16x16x32_bf16 v[40:43], a[88:91], v[136:139], v[40:43]
  ds_read_b128 v[68:71], v8 offset:28800
  v_mfma_f32_16x16x32_bf16 v[40:43], a[92:95], v[140:143], v[40:43]
  s_and_b32 s32, s25, 93184
  v_mfma_f32_16x16x32_bf16 v[40:43], a[96:99], v[144:147], v[40:43]
  v_cvt_pk_bf16_f32 v24, v36, v37
  v_mfma_f32_16x16x32_bf16 v[40:43], a[100:103], v[148:151], v[40:43]
  s_add_u32 m0, s24, s32
  v_mfma_f32_16x16x32_bf16 v[40:43], a[104:107], v[152:155], v[40:43]
  ds_read_b128 v[72:75], v9 offset:28672
  v_mfma_f32_16x16x32_bf16 v[40:43], a[108:111], v[156:159], v[40:43]
  buffer_load_dwordx4 v13, s[8:11], s27 offen lds
  v_mfma_f32_16x16x32_bf16 v[40:43], a[112:115], v[160:163], v[40:43]
  v_cvt_pk_bf16_f32 v25, v38, v39
  v_mfma_f32_16x16x32_bf16 v[40:43], a[116:119], v[164:167], v[40:43]
  s_add_u32 s27, s27, 43008
  v_mfma_f32_16x16x32_bf16 v[44:47], a[120:123], v[108:111], v[44:47]
  ds_read_b128 v[76:79], v9 offset:28736
  v_mfma_f32_16x16x32_bf16 v[44:47], a[124:127], v[112:115], v[44:47]
  s_sub_u32 s31, s27, 9633792
  v_mfma_f32_16x16x32_bf16 v[44:47], a[128:131], v[116:119], v[44:47]
  buffer_store_dwordx2 v[24:25], v16, s[16:19], s28 offen nt
  v_mfma_f32_16x16x32_bf16 v[44:47], a[132:135], v[120:123], v[44:47]
  s_min_u32 s27, s27, s31
  v_mfma_f32_16x16x32_bf16 v[44:47], a[136:139], v[124:127], v[44:47]
  s_add_u32 s28, s28, 43008
  v_mfma_f32_16x16x32_bf16 v[44:47], a[140:143], v[128:131], v[44:47]
  ds_read_b128 v[80:83], v9 offset:28800
  v_mfma_f32_16x16x32_bf16 v[44:47], a[144:147], v[132:135], v[44:47]
  v_mfma_f32_16x16x32_bf16 v[44:47], a[148:151], v[136:139], v[44:47]
  v_mfma_f32_16x16x32_bf16 v[44:47], a[152:155], v[140:143], v[44:47]
  v_mfma_f32_16x16x32_bf16 v[44:47], a[156:159], v[144:147], v[44:47]
  ds_read_b128 v[84:87], v10 offset:28672
  v_mfma_f32_16x16x32_bf16 v[44:47], a[160:163], v[148:151], v[44:47]
  v_mfma_f32_16x16x32_bf16 v[44:47], a[164:167], v[152:155], v[44:47]
  v_mfma_f32_16x16x32_bf16 v[44:47], a[168:171], v[156:159], v[44:47]
  v_mfma_f32_16x16x32_bf16 v[44:47], a[172:175], v[160:163], v[44:47]
  v_mfma_f32_16x16x32_bf16 v[44:47], a[176:179], v[164:167], v[44:47]
  ds_read_b128 v[88:91], v10 offset:28736
  v_mfma_f32_16x16x32_bf16 v[32:35], a[180:183], v[108:111], v[32:35]
  v_mfma_f32_16x16x32_bf16 v[32:35], a[184:187], v[112:115], v[32:35]
  v_mfma_f32_16x16x32_bf16 v[32:35], a[188:191], v[116:119], v[32:35]
  v_mfma_f32_16x16x32_bf16 v[32:35], a[192:195], v[120:123], v[32:35]
  ds_read_b128 v[92:95], v10 offset:28800
  v_mfma_f32_16x16x32_bf16 v[32:35], a[196:199], v[124:127], v[32:35]
  v_mfma_f32_16x16x32_bf16 v[32:35], a[200:203], v[128:131], v[32:35]
  v_mfma_f32_16x16x32_bf16 v[32:35], a[204:207], v[132:135], v[32:35]
  v_mfma_f32_16x16x32_bf16 v[32:35], a[208:211], v[136:139], v[32:35]
  ds_read_b128 v[96:99], v11 offset:28672
  v_mfma_f32_16x16x32_bf16 v[32:35], a[212:215], v[140:143], v[32:35]
  v_mfma_f32_16x16x32_bf16 v[32:35], a[216:219], v[144:147], v[32:35]
  v_mfma_f32_16x16x32_bf16 v[32:35], a[220:223], v[148:151], v[32:35]
  v_mfma_f32_16x16x32_bf16 v[32:35], a[224:227], v[152:155], v[32:35]
  v_mfma_f32_16x16x32_bf16 v[32:35], a[228:231], v[156:159], v[32:35]
  ds_read_b128 v[100:103], v11 offset:28736
  v_mfma_f32_16x16x32_bf16 v[32:35], a[232:235], v[160:163], v[32:35]
  v_mfma_f32_16x16x32_bf16 v[32:35], a[236:239], v[164:167], v[32:35]
  v_mfma_f32_16x16x32_bf16 v[36:39], a[240:243], v[108:111], 0
  v_mfma_f32_16x16x32_bf16 v[36:39], a[244:247], v[112:115], v[36:39]
  ds_read_b128 v[104:107], v11 offset:28800
  v_mfma_f32_16x16x32_bf16 v[36:39], a[248:251], v[116:119], v[36:39]
  v_mfma_f32_16x16x32_bf16 v[36:39], a[252:255], v[120:123], v[36:39]
  v_mfma_f32_16x16x32_bf16 v[36:39], v[212:215], v[124:127], v[36:39]
  v_mfma_f32_16x16x32_bf16 v[36:39], v[216:219], v[128:131], v[36:39]
  v_mfma_f32_16x16x32_bf16 v[36:39], v[220:223], v[132:135], v[36:39]
  v_mfma_f32_16x16x32_bf16 v[36:39], v[224:227], v[136:139], v[36:39]
  v_mfma_f32_16x16x32_bf16 v[36:39], v[228:231], v[140:143], v[36:39]
  v_mfma_f32_16x16x32_bf16 v[36:39], v[232:235], v[144:147], v[36:39]
  v_mfma_f32_16x16x32_bf16 v[36:39], v[236:239], v[148:151], v[36:39]
  v_mfma_f32_16x16x32_bf16 v[36:39], v[240:243], v[152:155], v[36:39]
  v_mfma_f32_16x16x32_bf16 v[36:39], v[244:247], v[156:159], v[36:39]
  s_waitcnt vmcnt(7)
  v_mfma_f32_16x16x32_bf16 v[36:39], v[248:251], v[160:163], v[36:39]
  s_waitcnt lgkmcnt(0)
  v_mfma_f32_16x16x32_bf16 v[36:39], v[252:255], v[164:167], v[36:39]
  s_barrier
  v_mfma_f32_16x16x32_bf16 v[40:43], a[0:3], v[48:51], v[40:43]
  ds_read_b128 v[108:111], v7 offset:35840
  v_mfma_f32_16x16x32_bf16 v[40:43], a[4:7], v[52:55], v[40:43]
  v_mfma_f32_16x16x32_bf16 v[40:43], a[8:11], v[56:59], v[40:43]
  v_mfma_f32_16x16x32_bf16 v[40:43], a[12:15], v[60:63], v[40:43]
  ds_read_b128 v[112:115], v7 offset:35904
  v_mfma_f32_16x16x32_bf16 v[40:43], a[16:19], v[64:67], v[40:43]
  v_mfma_f32_16x16x32_bf16 v[40:43], a[20:23], v[68:71], v[40:43]
  v_mfma_f32_16x16x32_bf16 v[40:43], a[24:27], v[72:75], v[40:43]
  ds_read_b128 v[116:119], v7 offset:35968
  v_mfma_f32_16x16x32_bf16 v[40:43], a[28:31], v[76:79], v[40:43]
  v_mfma_f32_16x16x32_bf16 v[40:43], a[32:35], v[80:83], v[40:43]
  v_mfma_f32_16x16x32_bf16 v[40:43], a[36:39], v[84:87], v[40:43]
  v_mfma_f32_16x16x32_bf16 v[40:43], a[40:43], v[88:91], v[40:43]
  ds_read_b128 v[120:123], v8 offset:35840
  v_mfma_f32_16x16x32_bf16 v[40:43], a[44:47], v[92:95], v[40:43]
  v_mfma_f32_16x16x32_bf16 v[40:43], a[48:51], v[96:99], v[40:43]
  v_mfma_f32_16x16x32_bf16 v[40:43], a[52:55], v[100:103], v[40:43]
  ds_read_b128 v[124:127], v8 offset:35904
  v_mfma_f32_16x16x32_bf16 v[40:43], a[56:59], v[104:107], v[40:43]
  v_mfma_f32_16x16x32_bf16 v[44:47], a[60:63], v[48:51], v[44:47]
  v_mfma_f32_16x16x32_bf16 v[44:47], a[64:67], v[52:55], v[44:47]
  v_mfma_f32_16x16x32_bf16 v[44:47], a[68:71], v[56:59], v[44:47]
  ds_read_b128 v[128:131], v8 offset:35968
  v_mfma_f32_16x16x32_bf16 v[44:47], a[72:75], v[60:63], v[44:47]
  s_add_u32 m0, s23, 100352
  v_mfma_f32_16x16x32_bf16 v[44:47], a[76:79], v[64:67], v[44:47]
  v_mfma_f32_16x16x32_bf16 v[44:47], a[80:83], v[68:71], v[44:47]
  ds_read_b128 v[132:135], v9 offset:35840
  v_mfma_f32_16x16x32_bf16 v[44:47], a[84:87], v[72:75], v[44:47]
  buffer_load_dwordx4 v12, s[8:11], s27 offen lds
  v_mfma_f32_16x16x32_bf16 v[44:47], a[88:91], v[76:79], v[44:47]
  v_mfma_f32_16x16x32_bf16 v[44:47], a[92:95], v[80:83], v[44:47]
  ds_read_b128 v[136:139], v9 offset:35904
  v_mfma_f32_16x16x32_bf16 v[44:47], a[96:99], v[84:87], v[44:47]
  s_and_b32 s32, s25, 100352
  v_mfma_f32_16x16x32_bf16 v[44:47], a[100:103], v[88:91], v[44:47]
  v_cvt_pk_bf16_f32 v24, v40, v41
  v_mfma_f32_16x16x32_bf16 v[44:47], a[104:107], v[92:95], v[44:47]
  s_add_u32 m0, s24, s32
  v_mfma_f32_16x16x32_bf16 v[44:47], a[108:111], v[96:99], v[44:47]
  ds_read_b128 v[140:143], v9 offset:35968
  v_mfma_f32_16x16x32_bf16 v[44:47], a[112:115], v[100:103], v[44:47]
  buffer_load_dwordx4 v13, s[8:11], s27 offen lds
  v_mfma_f32_16x16x32_bf16 v[44:47], a[116:119], v[104:107], v[44:47]
  v_cvt_pk_bf16_f32 v25, v42, v43
  v_mfma_f32_16x16x32_bf16 v[32:35], a[120:123], v[48:51], v[32:35]
  ds_read_b128 v[144:147], v10 offset:35840
  v_mfma_f32_16x16x32_bf16 v[32:35], a[124:127], v[52:55], v[32:35]
  s_add_u32 s27, s27, 43008
  v_mfma_f32_16x16x32_bf16 v[32:35], a[128:131], v[56:59], v[32:35]
  buffer_store_dwordx2 v[24:25], v16, s[16:19], s28 offen nt
  v_mfma_f32_16x16x32_bf16 v[32:35], a[132:135], v[60:63], v[32:35]
  s_sub_u32 s31, s27, 9633792
  v_mfma_f32_16x16x32_bf16 v[32:35], a[136:139], v[64:67], v[32:35]
  ds_read_b128 v[148:151], v10 offset:35904
  v_mfma_f32_16x16x32_bf16 v[32:35], a[140:143], v[68:71], v[32:35]
  s_min_u32 s27, s27, s31
  v_mfma_f32_16x16x32_bf16 v[32:35], a[144:147], v[72:75], v[32:35]
  s_add_u32 s28, s28, 43008
  v_mfma_f32_16x16x32_bf16 v[32:35], a[148:151], v[76:79], v[32:35]
  ds_read_b128 v[152:155], v10 offset:35968
  v_mfma_f32_16x16x32_bf16 v[32:35], a[152:155], v[80:83], v[32:35]
  v_mfma_f32_16x16x32_bf16 v[32:35], a[156:159], v[84:87], v[32:35]
  v_mfma_f32_16x16x32_bf16 v[32:35], a[160:163], v[88:91], v[32:35]
  ds_read_b128 v[156:159], v11 offset:35840
  v_mfma_f32_16x16x32_bf16 v[32:35], a[164:167], v[92:95], v[32:35]
  v_mfma_f32_16x16x32_bf16 v[32:35], a[168:171], v[96:99], v[32:35]
  v_mfma_f32_16x16x32_bf16 v[32:35], a[172:175], v[100:103], v[32:35]
  v_mfma_f32_16x16x32_bf16 v[32:35], a[176:179], v[104:107], v[32:35]
  ds_read_b128 v[160:163], v11 offset:35904
  v_mfma_f32_16x16x32_bf16 v[36:39], a[180:183], v[48:51], v[36:39]
  v_mfma_f32_16x16x32_bf16 v[36:39], a[184:187], v[52:55], v[36:39]
  v_mfma_f32_16x16x32_bf16 v[36:39], a[188:191], v[56:59], v[36:39]
  ds_read_b128 v[164:167], v11 offset:35968
  v_mfma_f32_16x16x32_bf16 v[36:39], a[192:195], v[60:63], v[36:39]
  v_mfma_f32_16x16x32_bf16 v[36:39], a[196:199], v[64:67], v[36:39]
  v_mfma_f32_16x16x32_bf16 v[36:39], a[200:203], v[68:71], v[36:39]
  v_mfma_f32_16x16x32_bf16 v[36:39], a[204:207], v[72:75], v[36:39]
  v_mfma_f32_16x16x32_bf16 v[36:39], a[208:211], v[76:79], v[36:39]
  v_mfma_f32_16x16x32_bf16 v[36:39], a[212:215], v[80:83], v[36:39]
  v_mfma_f32_16x16x32_bf16 v[36:39], a[216:219], v[84:87], v[36:39]
  v_mfma_f32_16x16x32_bf16 v[36:39], a[220:223], v[88:91], v[36:39]
  v_mfma_f32_16x16x32_bf16 v[36:39], a[224:227], v[92:95], v[36:39]
  v_mfma_f32_16x16x32_bf16 v[36:39], a[228:231], v[96:99], v[36:39]
  s_waitcnt vmcnt(7)
  v_mfma_f32_16x16x32_bf16 v[36:39], a[232:235], v[100:103], v[36:39]
  s_waitcnt lgkmcnt(0)
  v_mfma_f32_16x16x32_bf16 v[36:39], a[236:239], v[104:107], v[36:39]
  s_cmp_eq_u32 s29, s49
  s_cbranch_scc1 L_skipl2
  v_mfma_f32_16x16x32_bf16 v[40:43], a[240:243], v[48:51], 0
  v_mfma_f32_16x16x32_bf16 v[40:43], a[244:247], v[52:55], v[40:43]
  v_mfma_f32_16x16x32_bf16 v[40:43], a[248:251], v[56:59], v[40:43]
  v_mfma_f32_16x16x32_bf16 v[40:43], a[252:255], v[60:63], v[40:43]
  v_mfma_f32_16x16x32_bf16 v[40:43], v[212:215], v[64:67], v[40:43]
  v_mfma_f32_16x16x32_bf16 v[40:43], v[216:219], v[68:71], v[40:43]
  v_mfma_f32_16x16x32_bf16 v[40:43], v[220:223], v[72:75], v[40:43]
  v_mfma_f32_16x16x32_bf16 v[40:43], v[224:227], v[76:79], v[40:43]
  v_mfma_f32_16x16x32_bf16 v[40:43], v[228:231], v[80:83], v[40:43]
  v_mfma_f32_16x16x32_bf16 v[40:43], v[232:235], v[84:87], v[40:43]
  v_mfma_f32_16x16x32_bf16 v[40:43], v[236:239], v[88:91], v[40:43]
  v_mfma_f32_16x16x32_bf16 v[40:43], v[240:243], v[92:95], v[40:43]
  v_mfma_f32_16x16x32_bf16 v[40:43], v[244:247], v[96:99], v[40:43]
  v_mfma_f32_16x16x32_bf16 v[40:43], v[248:251], v[100:103], v[40:43]
  v_mfma_f32_16x16x32_bf16 v[40:43], v[252:255], v[104:107], v[40:43]
L_skipl2:
  s_cmp_eq_u32 s29, 0
  s_cbranch_scc1 L_down
  s_sub_u32 s29, s29, 1
  s_barrier
  v_mfma_f32_16x16x32_bf16 v[44:47], a[0:3], v[108:111], v[44:47]
  ds_read_b128 v[48:51], v7 offset:14336
  v_mfma_f32_16x16x32_bf16 v[44:47], a[4:7], v[112:115], v[44:47]
  v_mfma_f32_16x16x32_bf16 v[44:47], a[8:11], v[116:119], v[44:47]
  v_mfma_f32_16x16x32_bf16 v[44:47], a[12:15], v[120:123], v[44:47]
  v_mfma_f32_16x16x32_bf16 v[44:47], a[16:19], v[124:127], v[44:47]
  ds_read_b128 v[52:55], v7 offset:14400
  v_mfma_f32_16x16x32_bf16 v[44:47], a[20:23], v[128:131], v[44:47]
  v_mfma_f32_16x16x32_bf16 v[44:47], a[24:27], v[132:135], v[44:47]
  v_mfma_f32_16x16x32_bf16 v[44:47], a[28:31], v[136:139], v[44:47]
  v_mfma_f32_16x16x32_bf16 v[44:47], a[32:35], v[140:143], v[44:47]
  ds_read_b128 v[56:59], v7 offset:14464
  v_mfma_f32_16x16x32_bf16 v[44:47], a[36:39], v[144:147], v[44:47]
  v_mfma_f32_16x16x32_bf16 v[44:47], a[40:43], v[148:151], v[44:47]
  v_mfma_f32_16x16x32_bf16 v[44:47], a[44:47], v[152:155], v[44:47]
  v_mfma_f32_16x16x32_bf16 v[44:47], a[48:51], v[156:159], v[44:47]
  v_mfma_f32_16x16x32_bf16 v[44:47], a[52:55], v[160:163], v[44:47]
  ds_read_b128 v[60:63], v8 offset:14336
  v_mfma_f32_16x16x32_bf16 v[44:47], a[56:59], v[164:167], v[44:47]
  v_mfma_f32_16x16x32_bf16 v[32:35], a[60:63], v[108:111], v[32:35]
  v_mfma_f32_16x16x32_bf16 v[32:35], a[64:67], v[112:115], v[32:35]
  v_mfma_f32_16x16x32_bf16 v[32:35], a[68:71], v[116:119], v[32:35]
  ds_read_b128 v[64:67], v8 offset:14400
  v_mfma_f32_16x16x32_bf16 v[32:35], a[72:75], v[120:123], v[32:35]
  s_add_u32 m0, s23, 107520
  v_mfma_f32_16x16x32_bf16 v[32:35], a[76:79], v[124:127], v[32:35]
  v_mfma_f32_16x16x32_bf16 v[32:35], a[80:83], v[128:131], v[32:35]
  buffer_load_dwordx4 v12, s[8:11], s27 offen lds
  v_mfma_f32_16x16x32_bf16 v[32:35], a[84:87], v[132:135], v[32:35]
  v_mfma_f32_16x16x32_bf16 v[32:35], a[88:91], v[136:139], v[32:35]
  ds_read_b128 v[68:71], v8 offset:14464
  v_mfma_f32_16x16x32_bf16 v[32:35], a[92:95], v[140:143], v[32:35]
  s_and_b32 s32, s25, 107520
  v_mfma_f32_16x16x32_bf16 v[32:35], a[96:99], v[144:147], v[32:35]
  v_cvt_pk_bf16_f32 v24, v44, v45
  v_mfma_f32_16x16x32_bf16 v[32:35], a[100:103], v[148:151], v[32:35]
  s_add_u32 m0, s24, s32
  v_mfma_f32_16x16x32_bf16 v[32:35], a[104:107], v[152:155], v[32:35]
  ds_read_b128 v[72:75], v9 offset:14336
  v_mfma_f32_16x16x32_bf16 v[32:35], a[108:111], v[156:159], v[32:35]
  buffer_load_dwordx4 v13, s[8:11], s27 offen lds
  v_mfma_f32_16x16x32_bf16 v[32:35], a[112:115], v[160:163], v[32:35]
  v_cvt_pk_bf16_f32 v25, v46, v47
  v_mfma_f32_16x16x32_bf16 v[32:35], a[116:119], v[164:167], v[32:35]
  s_add_u32 s27, s27, 43008
  v_mfma_f32_16x16x32_bf16 v[36:39], a[120:123], v[108:111], v[36:39]
  ds_read_b128 v[76:79], v9 offset:14400
  v_mfma_f32_16x16x32_bf16 v[36:39], a[124:127], v[112:115], v[36:39]
  s_sub_u32 s31, s27, 9633792
  v_mfma_f32_16x16x32_bf16 v[36:39], a[128:131], v[116:119], v[36:39]
  buffer_store_dwordx2 v[24:25], v16, s[16:19], s28 offen nt
  v_mfma_f32_16x16x32_bf16 v[36:39], a[132:135], v[120:123], v[36:39]
  s_min_u32 s27, s27, s31
  v_mfma_f32_16x16x32_bf16 v[36:39], a[136:139], v[124:127], v[36:39]
  s_add_u32 s28, s28, 43008
  v_mfma_f32_16x16x32_bf16 v[36:39], a[140:143], v[128:131], v[36:39]
  ds_read_b128 v[80:83], v9 offset:14464
  v_mfma_f32_16x16x32_bf16 v[36:39], a[144:147], v[132:135], v[36:39]
  v_mfma_f32_16x16x32_bf16 v[36:39], a[148:151], v[136:139], v[36:39]
  v_mfma_f32_16x16x32_bf16 v[36:39], a[152:155], v[140:143], v[36:39]
  v_mfma_f32_16x16x32_bf16 v[36:39], a[156:159], v[144:147], v[36:39]
  ds_read_b128 v[84:87], v10 offset:14336
  v_mfma_f32_16x16x32_bf16 v[36:39], a[160:163], v[148:151], v[36:39]
  v_mfma_f32_16x16x32_bf16 v[36:39], a[164:167], v[152:155], v[36:39]
  v_mfma_f32_16x16x32_bf16 v[36:39], a[168:171], v[156:159], v[36:39]
  v_mfma_f32_16x16x32_bf16 v[36:39], a[172:175], v[160:163], v[36:39]
  v_mfma_f32_16x16x32_bf16 v[36:39], a[176:179], v[164:167], v[36:39]
  ds_read_b128 v[88:91], v10 offset:14400
  v_mfma_f32_16x16x32_bf16 v[40:43], a[180:183], v[108:111], v[40:43]
  v_mfma_f32_16x16x32_bf16 v[40:43], a[184:187], v[112:115], v[40:43]
  v_mfma_f32_16x16x32_bf16 v[40:43], a[188:191], v[116:119], v[40:43]
  v_mfma_f32_16x16x32_bf16 v[40:43], a[192:195], v[120:123], v[40:43]
  ds_read_b128 v[92:95], v10 offset:14464
  v_mfma_f32_16x16x32_bf16 v[40:43], a[196:199], v[124:127], v[40:43]
  v_mfma_f32_16x16x32_bf16 v[40:43], a[200:203], v[128:131], v[40:43]
  v_mfma_f32_16x16x32_bf16 v[40:43], a[204:207], v[132:135], v[40:43]
  v_mfma_f32_16x16x32_bf16 v[40:43], a[208:211], v[136:139], v[40:43]
  ds_read_b128 v[96:99], v11 offset:14336
  v_mfma_f32_16x16x32_bf16 v[40:43], a[212:215], v[140:143], v[40:43]
  v_mfma_f32_16x16x32_bf16 v[40:43], a[216:219], v[144:147], v[40:43]
  v_mfma_f32_16x16x32_bf16 v[40:43], a[220:223], v[148:151], v[40:43]
  v_mfma_f32_16x16x32_bf16 v[40:43], a[224:227], v[152:155], v[40:43]
  v_mfma_f32_16x16x32_bf16 v[40:43], a[228:231], v[156:159], v[40:43]
  ds_read_b128 v[100:103], v11 offset:14400
  v_mfma_f32_16x16x32_bf16 v[40:43], a[232:235], v[160:163], v[40:43]
  v_mfma_f32_16x16x32_bf16 v[40:43], a[236:239], v[164:167], v[40:43]
  v_mfma_f32_16x16x32_bf16 v[44:47], a[240:243], v[108:111], 0
  v_mfma_f32_16x16x32_bf16 v[44:47], a[244:247], v[112:115], v[44:47]
  ds_read_b128 v[104:107], v11 offset:14464
  v_mfma_f32_16x16x32_bf16 v[44:47], a[248:251], v[116:119], v[44:47]
  v_mfma_f32_16x16x32_bf16 v[44:47], a[252:255], v[120:123], v[44:47]
  v_mfma_f32_16x16x32_bf16 v[44:47], v[212:215], v[124:127], v[44:47]
  v_mfma_f32_16x16x32_bf16 v[44:47], v[216:219], v[128:131], v[44:47]
  v_mfma_f32_16x16x32_bf16 v[44:47], v[220:223], v[132:135], v[44:47]
  v_mfma_f32_16x16x32_bf16 v[44:47], v[224:227], v[136:139], v[44:47]
  v_mfma_f32_16x16x32_bf16 v[44:47], v[228:231], v[140:143], v[44:47]
  v_mfma_f32_16x16x32_bf16 v[44:47], v[232:235], v[144:147], v[44:47]
  v_mfma_f32_16x16x32_bf16 v[44:47], v[236:239], v[148:151], v[44:47]
  v_mfma_f32_16x16x32_bf16 v[44:47], v[240:243], v[152:155], v[44:47]
  v_mfma_f32_16x16x32_bf16 v[44:47], v[244:247], v[156:159], v[44:47]
  s_waitcnt vmcnt(7)
  v_mfma_f32_16x16x32_bf16 v[44:47], v[248:251], v[160:163], v[44:47]
  s_waitcnt lgkmcnt(0)
  v_mfma_f32_16x16x32_bf16 v[44:47], v[252:255], v[164:167], v[44:47]
  s_branch L_loop
L_down:
  s_barrier
  v_mfma_f32_16x16x32_bf16 v[44:47], a[0:3], v[108:111], v[44:47]
  ds_read_b128 v[48:51], v7 offset:14336
  v_mfma_f32_16x16x32_bf16 v[44:47], a[4:7], v[112:115], v[44:47]
  v_mfma_f32_16x16x32_bf16 v[44:47], a[8:11], v[116:119], v[44:47]
  ds_read_b128 v[52:55], v7 offset:14400
  v_mfma_f32_16x16x32_bf16 v[44:47], a[12:15], v[120:123], v[44:47]
  v_mfma_f32_16x16x32_bf16 v[44:47], a[16:19], v[124:127], v[44:47]
  ds_read_b128 v[56:59], v7 offset:14464
  v_mfma_f32_16x16x32_bf16 v[44:47], a[20:23], v[128:131], v[44:47]
  v_mfma_f32_16x16x32_bf16 v[44:47], a[24:27], v[132:135], v[44:47]
  v_mfma_f32_16x16x32_bf16 v[44:47], a[28:31], v[136:139], v[44:47]
  ds_read_b128 v[60:63], v8 offset:14336
  v_mfma_f32_16x16x32_bf16 v[44:47], a[32:35], v[140:143], v[44:47]
  v_mfma_f32_16x16x32_bf16 v[44:47], a[36:39], v[144:147], v[44:47]
  ds_read_b128 v[64:67], v8 offset:14400
  v_mfma_f32_16x16x32_bf16 v[44:47], a[40:43], v[148:151], v[44:47]
  v_mfma_f32_16x16x32_bf16 v[44:47], a[44:47], v[152:155], v[44:47]
  v_mfma_f32_16x16x32_bf16 v[44:47], a[48:51], v[156:159], v[44:47]
  ds_read_b128 v[68:71], v8 offset:14464
  v_mfma_f32_16x16x32_bf16 v[44:47], a[52:55], v[160:163], v[44:47]
  v_mfma_f32_16x16x32_bf16 v[44:47], a[56:59], v[164:167], v[44:47]
  ds_read_b128 v[72:75], v9 offset:14336
  v_mfma_f32_16x16x32_bf16 v[32:35], a[60:63], v[108:111], v[32:35]
  v_mfma_f32_16x16x32_bf16 v[32:35], a[64:67], v[112:115], v[32:35]
  ds_read_b128 v[76:79], v9 offset:14400
  v_mfma_f32_16x16x32_bf16 v[32:35], a[68:71], v[116:119], v[32:35]
  v_mfma_f32_16x16x32_bf16 v[32:35], a[72:75], v[120:123], v[32:35]
  v_mfma_f32_16x16x32_bf16 v[32:35], a[76:79], v[124:127], v[32:35]
  ds_read_b128 v[80:83], v9 offset:14464
  v_mfma_f32_16x16x32_bf16 v[32:35], a[80:83], v[128:131], v[32:35]
  v_mfma_f32_16x16x32_bf16 v[32:35], a[84:87], v[132:135], v[32:35]
  ds_read_b128 v[84:87], v10 offset:14336
  v_mfma_f32_16x16x32_bf16 v[32:35], a[88:91], v[136:139], v[32:35]
  v_mfma_f32_16x16x32_bf16 v[32:35], a[92:95], v[140:143], v[32:35]
  v_cvt_pk_bf16_f32 v24, v44, v45
  v_mfma_f32_16x16x32_bf16 v[32:35], a[96:99], v[144:147], v[32:35]
  ds_read_b128 v[88:91], v10 offset:14400
  v_mfma_f32_16x16x32_bf16 v[32:35], a[100:103], v[148:151], v[32:35]
  v_cvt_pk_bf16_f32 v25, v46, v47
  v_mfma_f32_16x16x32_bf16 v[32:35], a[104:107], v[152:155], v[32:35]
  ds_read_b128 v[92:95], v10 offset:14464
  v_mfma_f32_16x16x32_bf16 v[32:35], a[108:111], v[156:159], v[32:35]
  buffer_store_dwordx2 v[24:25], v16, s[16:19], s28 offen nt
  v_mfma_f32_16x16x32_bf16 v[32:35], a[112:115], v[160:163], v[32:35]
  ds_read_b128 v[96:99], v11 offset:14336
  v_mfma_f32_16x16x32_bf16 v[32:35], a[116:119], v[164:167], v[32:35]
  s_add_u32 s28, s28, 43008
  v_mfma_f32_16x16x32_bf16 v[36:39], a[120:123], v[108:111], v[36:39]
  v_mfma_f32_16x16x32_bf16 v[36:39], a[124:127], v[112:115], v[36:39]
  ds_read_b128 v[100:103], v11 offset:14400
  v_mfma_f32_16x16x32_bf16 v[36:39], a[128:131], v[116:119], v[36:39]
  v_mfma_f32_16x16x32_bf16 v[36:39], a[132:135], v[120:123], v[36:39]
  ds_read_b128 v[104:107], v11 offset:14464
  v_mfma_f32_16x16x32_bf16 v[36:39], a[136:139], v[124:127], v[36:39]
  v_mfma_f32_16x16x32_bf16 v[36:39], a[140:143], v[128:131], v[36:39]
  v_mfma_f32_16x16x32_bf16 v[36:39], a[144:147], v[132:135], v[36:39]
  v_mfma_f32_16x16x32_bf16 v[36:39], a[148:151], v[136:139], v[36:39]
  v_mfma_f32_16x16x32_bf16 v[36:39], a[152:155], v[140:143], v[36:39]
  v_mfma_f32_16x16x32_bf16 v[36:39], a[156:159], v[144:147], v[36:39]
  v_mfma_f32_16x16x32_bf16 v[36:39], a[160:163], v[148:151], v[36:39]
  v_mfma_f32_16x16x32_bf16 v[36:39], a[164:167], v[152:155], v[36:39]
  v_mfma_f32_16x16x32_bf16 v[36:39], a[168:171], v[156:159], v[36:39]
  s_waitcnt vmcnt(5)
  v_mfma_f32_16x16x32_bf16 v[36:39], a[172:175], v[160:163], v[36:39]
  s_waitcnt lgkmcnt(0)
  v_mfma_f32_16x16x32_bf16 v[36:39], a[176:179], v[164:167], v[36:39]
  s_cmp_eq_u32 s49, 0
  s_cbranch_scc1 L_skip19
  v_mfma_f32_16x16x32_bf16 v[40:43], a[180:183], v[108:111], v[40:43]
  v_mfma_f32_16x16x32_bf16 v[40:43], a[184:187], v[112:115], v[40:43]
  v_mfma_f32_16x16x32_bf16 v[40:43], a[188:191], v[116:119], v[40:43]
  v_mfma_f32_16x16x32_bf16 v[40:43], a[192:195], v[120:123], v[40:43]
  v_mfma_f32_16x16x32_bf16 v[40:43], a[196:199], v[124:127], v[40:43]
  v_mfma_f32_16x16x32_bf16 v[40:43], a[200:203], v[128:131], v[40:43]
  v_mfma_f32_16x16x32_bf16 v[40:43], a[204:207], v[132:135], v[40:43]
  v_mfma_f32_16x16x32_bf16 v[40:43], a[208:211], v[136:139], v[40:43]
  v_mfma_f32_16x16x32_bf16 v[40:43], a[212:215], v[140:143], v[40:43]
  v_mfma_f32_16x16x32_bf16 v[40:43], a[216:219], v[144:147], v[40:43]
  v_mfma_f32_16x16x32_bf16 v[40:43], a[220:223], v[148:151], v[40:43]
  v_mfma_f32_16x16x32_bf16 v[40:43], a[224:227], v[152:155], v[40:43]
  v_mfma_f32_16x16x32_bf16 v[40:43], a[228:231], v[156:159], v[40:43]
  v_mfma_f32_16x16x32_bf16 v[40:43], a[232:235], v[160:163], v[40:43]
  v_mfma_f32_16x16x32_bf16 v[40:43], a[236:239], v[164:167], v[40:43]
L_skip19:
  s_barrier
  v_mfma_f32_16x16x32_bf16 v[32:35], a[0:3], v[48:51], v[32:35]
  ds_read_b128 v[108:111], v7 offset:21504
  v_mfma_f32_16x16x32_bf16 v[32:35], a[4:7], v[52:55], v[32:35]
  ds_read_b128 v[112:115], v7 offset:21568
  v_mfma_f32_16x16x32_bf16 v[32:35], a[8:11], v[56:59], v[32:35]
  ds_read_b128 v[116:119], v7 offset:21632
  v_mfma_f32_16x16x32_bf16 v[32:35], a[12:15], v[60:63], v[32:35]
  v_mfma_f32_16x16x32_bf16 v[32:35], a[16:19], v[64:67], v[32:35]
  ds_read_b128 v[120:123], v8 offset:21504
  v_mfma_f32_16x16x32_bf16 v[32:35], a[20:23], v[68:71], v[32:35]
  ds_read_b128 v[124:127], v8 offset:21568
  v_mfma_f32_16x16x32_bf16 v[32:35], a[24:27], v[72:75], v[32:35]
  v_mfma_f32_16x16x32_bf16 v[32:35], a[28:31], v[76:79], v[32:35]
  ds_read_b128 v[128:131], v8 offset:21632
  v_mfma_f32_16x16x32_bf16 v[32:35], a[32:35], v[80:83], v[32:35]
  ds_read_b128 v[132:135], v9 offset:21504
  v_mfma_f32_16x16x32_bf16 v[32:35], a[36:39], v[84:87], v[32:35]
  ds_read_b128 v[136:139], v9 offset:21568
  v_mfma_f32_16x16x32_bf16 v[32:35], a[40:43], v[88:91], v[32:35]
  v_mfma_f32_16x16x32_bf16 v[32:35], a[44:47], v[92:95], v[32:35]
  ds_read_b128 v[140:143], v9 offset:21632
  v_mfma_f32_16x16x32_bf16 v[32:35], a[48:51], v[96:99], v[32:35]
  ds_read_b128 v[144:147], v10 offset:21504
  v_mfma_f32_16x16x32_bf16 v[32:35], a[52:55], v[100:103], v[32:35]
  v_mfma_f32_16x16x32_bf16 v[32:35], a[56:59], v[104:107], v[32:35]
  ds_read_b128 v[148:151], v10 offset:21568
  v_mfma_f32_16x16x32_bf16 v[36:39], a[60:63], v[48:51], v[36:39]
  ds_read_b128 v[152:155], v10 offset:21632
  v_mfma_f32_16x16x32_bf16 v[36:39], a[64:67], v[52:55], v[36:39]
  ds_read_b128 v[156:159], v11 offset:21504
  v_mfma_f32_16x16x32_bf16 v[36:39], a[68:71], v[56:59], v[36:39]
  v_mfma_f32_16x16x32_bf16 v[36:39], a[72:75], v[60:63], v[36:39]
  ds_read_b128 v[160:163], v11 offset:21568
  v_mfma_f32_16x16x32_bf16 v[36:39], a[76:79], v[64:67], v[36:39]
  ds_read_b128 v[164:167], v11 offset:21632
  v_mfma_f32_16x16x32_bf16 v[36:39], a[80:83], v[68:71], v[36:39]
  v_mfma_f32_16x16x32_bf16 v[36:39], a[84:87], v[72:75], v[36:39]
  v_mfma_f32_16x16x32_bf16 v[36:39], a[88:91], v[76:79], v[36:39]
  v_mfma_f32_16x16x32_bf16 v[36:39], a[92:95], v[80:83], v[36:39]
  v_cvt_pk_bf16_f32 v24, v32, v33
  v_mfma_f32_16x16x32_bf16 v[36:39], a[96:99], v[84:87], v[36:39]
  v_cvt_pk_bf16_f32 v25, v34, v35
  v_mfma_f32_16x16x32_bf16 v[36:39], a[100:103], v[88:91], v[36:39]
  buffer_store_dwordx2 v[24:25], v16, s[16:19], s28 offen nt
  v_mfma_f32_16x16x32_bf16 v[36:39], a[104:107], v[92:95], v[36:39]
  s_add_u32 s28, s28, 43008
  v_mfma_f32_16x16x32_bf16 v[36:39], a[108:111], v[96:99], v[36:39]
  s_waitcnt vmcnt(3)
  v_mfma_f32_16x16x32_bf16 v[36:39], a[112:115], v[100:103], v[36:39]
  v_mfma_f32_16x16x32_bf16 v[36:39], a[116:119], v[104:107], v[36:39]
  s_cmp_eq_u32 s49, 0
  s_cbranch_scc1 L_skip20
  v_mfma_f32_16x16x32_bf16 v[40:43], a[120:123], v[48:51], v[40:43]
  v_mfma_f32_16x16x32_bf16 v[40:43], a[124:127], v[52:55], v[40:43]
  v_mfma_f32_16x16x32_bf16 v[40:43], a[128:131], v[56:59], v[40:43]
  v_mfma_f32_16x16x32_bf16 v[40:43], a[132:135], v[60:63], v[40:43]
  v_mfma_f32_16x16x32_bf16 v[40:43], a[136:139], v[64:67], v[40:43]
  v_mfma_f32_16x16x32_bf16 v[40:43], a[140:143], v[68:71], v[40:43]
  v_mfma_f32_16x16x32_bf16 v[40:43], a[144:147], v[72:75], v[40:43]
  v_mfma_f32_16x16x32_bf16 v[40:43], a[148:151], v[76:79], v[40:43]
  v_mfma_f32_16x16x32_bf16 v[40:43], a[152:155], v[80:83], v[40:43]
  v_mfma_f32_16x16x32_bf16 v[40:43], a[156:159], v[84:87], v[40:43]
  v_mfma_f32_16x16x32_bf16 v[40:43], a[160:163], v[88:91], v[40:43]
  v_mfma_f32_16x16x32_bf16 v[40:43], a[164:167], v[92:95], v[40:43]
  v_mfma_f32_16x16x32_bf16 v[40:43], a[168:171], v[96:99], v[40:43]
  v_mfma_f32_16x16x32_bf16 v[40:43], a[172:175], v[100:103], v[40:43]
  v_mfma_f32_16x16x32_bf16 v[40:43], a[176:179], v[104:107], v[40:43]
L_skip20:
  s_waitcnt lgkmcnt(0)
  s_barrier
  v_mfma_f32_16x16x32_bf16 v[36:39], a[0:3], v[108:111], v[36:39]
  ds_read_b128 v[48:51], v7 offset:28672
  v_mfma_f32_16x16x32_bf16 v[36:39], a[4:7], v[112:115], v[36:39]
  ds_read_b128 v[52:55], v7 offset:28736
  v_mfma_f32_16x16x32_bf16 v[36:39], a[8:11], v[116:119], v[36:39]
  ds_read_b128 v[56:59], v7 offset:28800
  v_mfma_f32_16x16x32_bf16 v[36:39], a[12:15], v[120:123], v[36:39]
  ds_read_b128 v[60:63], v8 offset:28672
  v_mfma_f32_16x16x32_bf16 v[36:39], a[16:19], v[124:127], v[36:39]
  ds_read_b128 v[64:67], v8 offset:28736
  v_mfma_f32_16x16x32_bf16 v[36:39], a[20:23], v[128:131], v[36:39]
  ds_read_b128 v[68:71], v8 offset:28800
  v_mfma_f32_16x16x32_bf16 v[36:39], a[24:27], v[132:135], v[36:39]
  ds_read_b128 v[72:75], v9 offset:28672
  v_mfma_f32_16x16x32_bf16 v[36:39], a[28:31], v[136:139], v[36:39]
  ds_read_b128 v[76:79], v9 offset:28736
  v_mfma_f32_16x16x32_bf16 v[36:39], a[32:35], v[140:143], v[36:39]
  ds_read_b128 v[80:83], v9 offset:28800
  v_mfma_f32_16x16x32_bf16 v[36:39], a[36:39], v[144:147], v[36:39]
  ds_read_b128 v[84:87], v10 offset:28672
  v_mfma_f32_16x16x32_bf16 v[36:39], a[40:43], v[148:151], v[36:39]
  ds_read_b128 v[88:91], v10 offset:28736
  v_mfma_f32_16x16x32_bf16 v[36:39], a[44:47], v[152:155], v[36:39]
  ds_read_b128 v[92:95], v10 offset:28800
  v_mfma_f32_16x16x32_bf16 v[36:39], a[48:51], v[156:159], v[36:39]
  ds_read_b128 v[96:99], v11 offset:28672
  v_mfma_f32_16x16x32_bf16 v[36:39], a[52:55], v[160:163], v[36:39]
  ds_read_b128 v[100:103], v11 offset:28736
  v_mfma_f32_16x16x32_bf16 v[36:39], a[56:59], v[164:167], v[36:39]
  ds_read_b128 v[104:107], v11 offset:28800
  s_cmp_eq_u32 s49, 0
  s_cbranch_scc1 L_skip21
  v_mfma_f32_16x16x32_bf16 v[40:43], a[60:63], v[108:111], v[40:43]
  v_mfma_f32_16x16x32_bf16 v[40:43], a[64:67], v[112:115], v[40:43]
  v_mfma_f32_16x16x32_bf16 v[40:43], a[68:71], v[116:119], v[40:43]
  v_mfma_f32_16x16x32_bf16 v[40:43], a[72:75], v[120:123], v[40:43]
  v_mfma_f32_16x16x32_bf16 v[40:43], a[76:79], v[124:127], v[40:43]
  v_mfma_f32_16x16x32_bf16 v[40:43], a[80:83], v[128:131], v[40:43]
  v_mfma_f32_16x16x32_bf16 v[40:43], a[84:87], v[132:135], v[40:43]
  v_mfma_f32_16x16x32_bf16 v[40:43], a[88:91], v[136:139], v[40:43]
  v_mfma_f32_16x16x32_bf16 v[40:43], a[92:95], v[140:143], v[40:43]
  v_cvt_pk_bf16_f32 v24, v36, v37
  v_mfma_f32_16x16x32_bf16 v[40:43], a[96:99], v[144:147], v[40:43]
  v_cvt_pk_bf16_f32 v25, v38, v39
  v_mfma_f32_16x16x32_bf16 v[40:43], a[100:103], v[148:151], v[40:43]
  buffer_store_dwordx2 v[24:25], v16, s[16:19], s28 offen nt
  v_mfma_f32_16x16x32_bf16 v[40:43], a[104:107], v[152:155], v[40:43]
  s_add_u32 s28, s28, 43008
  v_mfma_f32_16x16x32_bf16 v[40:43], a[108:111], v[156:159], v[40:43]
  v_mfma_f32_16x16x32_bf16 v[40:43], a[112:115], v[160:163], v[40:43]
  v_mfma_f32_16x16x32_bf16 v[40:43], a[116:119], v[164:167], v[40:43]
  s_branch L_join21
L_skip21:
  s_nop 7
  s_nop 1
  v_cvt_pk_bf16_f32 v24, v36, v37
  v_cvt_pk_bf16_f32 v25, v38, v39
  buffer_store_dwordx2 v[24:25], v16, s[16:19], s28 offen nt
  s_add_u32 s28, s28, 43008
L_join21:
  s_cmp_eq_u32 s49, 0
  s_cbranch_scc1 L_done
  s_waitcnt lgkmcnt(0)
  v_mfma_f32_16x16x32_bf16 v[40:43], a[0:3], v[48:51], v[40:43]
  v_mfma_f32_16x16x32_bf16 v[40:43], a[4:7], v[52:55], v[40:43]
  v_mfma_f32_16x16x32_bf16 v[40:43], a[8:11], v[56:59], v[40:43]
  v_mfma_f32_16x16x32_bf16 v[40:43], a[12:15], v[60:63], v[40:43]
  v_mfma_f32_16x16x32_bf16 v[40:43], a[16:19], v[64:67], v[40:43]
  v_mfma_f32_16x16x32_bf16 v[40:43], a[20:23], v[68:71], v[40:43]
  v_mfma_f32_16x16x32_bf16 v[40:43], a[24:27], v[72:75], v[40:43]
  v_mfma_f32_16x16x32_bf16 v[40:43], a[28:31], v[76:79], v[40:43]
  v_mfma_f32_16x16x32_bf16 v[40:43], a[32:35], v[80:83], v[40:43]
  v_mfma_f32_16x16x32_bf16 v[40:43], a[36:39], v[84:87], v[40:43]
  v_mfma_f32_16x16x32_bf16 v[40:43], a[40:43], v[88:91], v[40:43]
  v_mfma_f32_16x16x32_bf16 v[40:43], a[44:47], v[92:95], v[40:43]
  v_mfma_f32_16x16x32_bf16 v[40:43], a[48:51], v[96:99], v[40:43]
  v_mfma_f32_16x16x32_bf16 v[40:43], a[52:55], v[100:103], v[40:43]
  v_mfma_f32_16x16x32_bf16 v[40:43], a[56:59], v[104:107], v[40:43]
  s_nop 7
  s_nop 1
  s_add_u32 s28, s28, s41
  v_cvt_pk_bf16_f32 v24, v40, v41
  v_cvt_pk_bf16_f32 v25, v42, v43
  buffer_store_dwordx2 v[24:25], v16, s[16:19], s28 offen nt
  s_add_u32 s28, s28, 43008
L_done:
  s_waitcnt vmcnt(0)
L_end:
  s_endpgm
L_code_end:
.section .rodata,"a"
.p2align 6
.amdhsa_kernel standalone__fft_conv__vision_kernel
  .amdhsa_next_free_vgpr 512
  .amdhsa_next_free_sgpr 64
  .amdhsa_accum_offset 256
  .amdhsa_group_segment_fixed_size 0
  .amdhsa_kernarg_size 40
  .amdhsa_user_sgpr_count 2
  .amdhsa_user_sgpr_kernarg_segment_ptr 1
  .amdhsa_system_sgpr_workgroup_id_x 1
.end_amdhsa_kernel
```
